```python
import torch

def _softmax(x, axis=-1):
    return torch.softmax(x, dim=axis)
def _gelu(x):
    return torch.nn.functional.gelu(x, approximate="tanh")
def _silu(x):
    return torch.nn.functional.silu(x)
def _sigmoid(x):
    return torch.sigmoid(x)
def _layernorm(x, axis=-1, eps=1e-5):
    m = x.mean(dim=axis, keepdim=True)
    v = x.var(dim=axis, keepdim=True, unbiased=False)
    return (x - m) / torch.sqrt(v + eps)
def _scatter_add(tgt, idx, src, axis=0):
    return tgt.clone().index_add_(axis, idx, src)
def _segment_sum(src, seg, n):
    out = torch.zeros((n,) + src.shape[1:], dtype=src.dtype)
    return out.index_add_(0, seg, src)
def _pad(x, pw):
    flat = tuple(v for pair in reversed(pw) for v in pair)
    return torch.nn.functional.pad(x, flat)

kernel_name = 'parallel_sum__softmax_full_mha__moe_arch_mod__prompt'

def setup_inputs():

    _w = (lambda a: (lambda t: t.to(torch.bfloat16) if t.is_floating_point() else t)(torch.as_tensor(a)))
    def _A_setup():
        B, S, D = 1, 2048, 512
        return {
            "x": _w((lambda *s: torch.randn(*s, dtype=torch.bfloat16) * 0.05)(B, S, D)),
            "wqkv": _w((lambda *s: torch.randn(*s, dtype=torch.bfloat16) * 0.2)(D, 3 * D)),
            "wo": _w((lambda *s: torch.randn(*s, dtype=torch.bfloat16) * 0.2)(D, D)),
        }
    _A_in = _A_setup()

    def _B_setup():
        B, S, D, F, C = 1, 2048, 512, 1376, 8
        return {
            "x": _w((lambda *s: torch.randn(*s, dtype=torch.bfloat16) * 0.05)(B, S, D)),
            "w_r": _w((lambda *s: torch.randn(*s, dtype=torch.bfloat16) * 1.6)(D)),
            "w_gate": _w((lambda *s: torch.randn(*s, dtype=torch.bfloat16) * 0.2)(D, F)),
            "w_up": _w((lambda *s: torch.randn(*s, dtype=torch.bfloat16) * 0.2)(D, F)),
            "w_down": _w((lambda *s: torch.randn(*s, dtype=torch.bfloat16) * 0.2)(F, D)),
        }
    _B_in = _B_setup()

    return {
        "A_x": _A_in["x"],
        "A_wqkv": _A_in["wqkv"],
        "A_wo": _A_in["wo"],
        "B_x": _B_in["x"],
        "B_w_r": _B_in["w_r"],
        "B_w_gate": _B_in["w_gate"],
        "B_w_up": _B_in["w_up"],
        "B_w_down": _B_in["w_down"],
    }

def reference(A_x, A_wqkv, A_wo, B_x, B_w_r, B_w_gate, B_w_up, B_w_down):
    def _A_ref(x, wqkv, wo):
        B, S, D = x.shape
        H = 32; Dh = D // H
        qkv = (lambda x, *d: x.permute(*d))((x @ wqkv).reshape(B, S, 3, H, Dh), 2, 0, 3, 1, 4)
        q, k, v = qkv[0], qkv[1], qkv[2]
        scale = Dh ** -0.5
        scores = torch.einsum("bhqd,bhkd->bhqk", q, k) * scale
        p = _softmax(scores, axis=-1)
        o = torch.einsum("bhqk,bhkd->bhqd", p, v)
        return (lambda x, *d: x.permute(*d))(o, 0, 2, 1, 3).reshape(B, S, D) @ wo

    def _B_ref(x, w_r, w_gate, w_up, w_down):
        B, S, D = x.shape
        C = 8
        r = x @ w_r
        idx = torch.argsort(-r, axis=-1)[:, :C]
        idx_e = (lambda x, n, axis: torch.repeat_interleave(x, n, dim=axis))(idx.reshape(B, C, 1), D, axis=2)
        x_sel = (lambda x, i, axis: torch.take_along_dim(x, i, dim=axis))(x, idx_e, axis=1)
        g = _silu(x_sel @ w_gate)
        u = x_sel @ w_up
        y = (g * u) @ w_down
        r_sel = _sigmoid((lambda x, i, axis: torch.take_along_dim(x, i, dim=axis))(r, idx, axis=1))
        y = y * r_sel.reshape(B, C, 1)
        b_off = (torch.arange(B) * S).reshape(B, 1)
        flat_idx = (idx + b_off).reshape(B * C)
        zero = (x * 0.0).reshape(B * S, D)
        upd = _scatter_add(zero, flat_idx, y.reshape(B * C, D), axis=0)
        return x + upd.reshape(B, S, D)

    x = A_x
    xn = _layernorm(x, axis=-1)
    return x + _A_ref(xn, A_wqkv, A_wo) + _B_ref(xn, B_w_r, B_w_gate, B_w_up, B_w_down)
```

```asm
; @launch kernel=k1_kernel grid=(256,1,1) block=(256,1,1) lds=152576
; @launch kernel=k2_kernel grid=(256,1,1) block=(576,1,1) lds=163840
; @launch kernel=k3_kernel grid=(256,1,1) block=(256,1,1) lds=98304
.amdgcn_target "amdgcn-amd-amdhsa--gfx950"
.text
.globl k1_kernel
.p2align 8
.type k1_kernel,@function
k1_kernel:
    s_cmp_ge_u32 s2, 256
    s_cbranch_scc1 k1_end
    s_memtime s[60:61]
    s_load_dwordx4 s[4:7], s[0:1], 0
    s_load_dwordx2 s[8:9], s[0:1], 32
    s_load_dwordx2 s[10:11], s[0:1], 80
    s_lshr_b32 s28, s2, 3
    s_and_b32 s29, s2, 7
    v_lshrrev_b32 v1, 6, v0
    v_and_b32 v2, 63, v0
    v_lshrrev_b32 v3, 4, v2
    v_and_b32 v4, 15, v2
    v_readfirstlane_b32 s30, v1
    s_mov_b32 s40, 0x3f803f80
    s_mov_b32 s41, 0x00003f80
    s_mov_b32 s42, 0x3f800000
    s_mov_b32 s32, 0
    s_mov_b32 s33, 4096
    s_mov_b32 s34, 8192
    s_mov_b32 s35, 12288
    s_waitcnt lgkmcnt(0)

    s_mov_b32 s12, s4
    s_and_b32 s13, s5, 0xffff
    s_mov_b32 s14, 2097152
    s_mov_b32 s15, 0x00020000
    s_mov_b32 s16, s6
    s_and_b32 s17, s7, 0xffff
    s_mov_b32 s18, 1572864
    s_mov_b32 s19, 0x00020000
    s_mov_b32 s20, s8
    s_and_b32 s21, s9, 0xffff
    s_mov_b32 s22, 1024
    s_mov_b32 s23, 0x00020000
    s_mov_b32 s24, s10
    s_and_b32 s25, s11, 0xffff
    s_mov_b32 s26, 16777216
    s_mov_b32 s27, 0x00020000
    s_lshl_b32 s31, s28, 6
    s_lshl_b32 s36, s30, 4
    s_add_u32 s31, s31, s36
    v_add_u32 v5, s31, v3
    v_lshlrev_b32 v8, 2, v5
    v_lshlrev_b32 v5, 10, v5
    v_lshl_add_u32 v5, v4, 4, v5

    v_add_u32 v6, s36, v3
    v_mul_u32_u24 v6, 1040, v6
    v_lshl_add_u32 v6, v4, 4, v6

    buffer_load_dwordx4 v[64:67], v5, s[12:15], s32 offen offset:0
    buffer_load_dwordx4 v[68:71], v5, s[12:15], s32 offen offset:256
    buffer_load_dwordx4 v[72:75], v5, s[12:15], s32 offen offset:512
    buffer_load_dwordx4 v[76:79], v5, s[12:15], s32 offen offset:768
    v_lshlrev_b32 v9, 4, v4
    buffer_load_dwordx4 v[48:51], v9, s[20:23], 0 offen offset:0
    buffer_load_dwordx4 v[52:55], v9, s[20:23], 0 offen offset:256
    buffer_load_dwordx4 v[56:59], v9, s[20:23], 0 offen offset:512
    buffer_load_dwordx4 v[60:63], v9, s[20:23], 0 offen offset:768
    buffer_load_dwordx4 v[80:83], v5, s[12:15], s33 offen offset:0
    buffer_load_dwordx4 v[84:87], v5, s[12:15], s33 offen offset:256
    buffer_load_dwordx4 v[88:91], v5, s[12:15], s33 offen offset:512
    buffer_load_dwordx4 v[92:95], v5, s[12:15], s33 offen offset:768
    buffer_load_dwordx4 v[96:99], v5, s[12:15], s34 offen offset:0
    buffer_load_dwordx4 v[100:103], v5, s[12:15], s34 offen offset:256
    buffer_load_dwordx4 v[104:107], v5, s[12:15], s34 offen offset:512
    buffer_load_dwordx4 v[108:111], v5, s[12:15], s34 offen offset:768
    buffer_load_dwordx4 v[112:115], v5, s[12:15], s35 offen offset:0
    buffer_load_dwordx4 v[116:119], v5, s[12:15], s35 offen offset:256
    buffer_load_dwordx4 v[120:123], v5, s[12:15], s35 offen offset:512
    buffer_load_dwordx4 v[124:127], v5, s[12:15], s35 offen offset:768
    s_mul_i32 s37, s30, 448
    s_lshl_b32 s38, s29, 7
    v_add_u32 v9, s37, v2
    v_add_u32 v9, 0, v9
    v_mul_u32_u24 v10, 2341, v9
    v_lshrrev_b32 v10, 16, v10
    v_mul_u32_u24 v11, 28, v10
    v_sub_u32 v11, v9, v11
    v_subrev_u32 v12, 4, v11
    v_cmp_gt_u32 vcc, 24, v11
    s_nop 1
    v_cndmask_b32 v11, v12, v11, vcc
    v_mul_u32_u24 v10, 3072, v10
    v_lshrrev_b32 v12, 3, v11
    v_lshl_add_u32 v10, v12, 10, v10
    v_and_b32 v11, 7, v11
    v_lshl_add_u32 v10, v11, 4, v10
    v_add_u32 v128, s38, v10

    v_add_u32 v9, s37, v2
    v_add_u32 v9, 64, v9
    v_mul_u32_u24 v10, 2341, v9
    v_lshrrev_b32 v10, 16, v10
    v_mul_u32_u24 v11, 28, v10
    v_sub_u32 v11, v9, v11
    v_subrev_u32 v12, 4, v11
    v_cmp_gt_u32 vcc, 24, v11
    s_nop 1
    v_cndmask_b32 v11, v12, v11, vcc
    v_mul_u32_u24 v10, 3072, v10
    v_lshrrev_b32 v12, 3, v11
    v_lshl_add_u32 v10, v12, 10, v10
    v_and_b32 v11, 7, v11
    v_lshl_add_u32 v10, v11, 4, v10
    v_add_u32 v129, s38, v10

    v_add_u32 v9, s37, v2
    v_add_u32 v9, 128, v9
    v_mul_u32_u24 v10, 2341, v9
    v_lshrrev_b32 v10, 16, v10
    v_mul_u32_u24 v11, 28, v10
    v_sub_u32 v11, v9, v11
    v_subrev_u32 v12, 4, v11
    v_cmp_gt_u32 vcc, 24, v11
    s_nop 1
    v_cndmask_b32 v11, v12, v11, vcc
    v_mul_u32_u24 v10, 3072, v10
    v_lshrrev_b32 v12, 3, v11
    v_lshl_add_u32 v10, v12, 10, v10
    v_and_b32 v11, 7, v11
    v_lshl_add_u32 v10, v11, 4, v10
    v_add_u32 v130, s38, v10

    v_add_u32 v9, s37, v2
    v_add_u32 v9, 192, v9
    v_mul_u32_u24 v10, 2341, v9
    v_lshrrev_b32 v10, 16, v10
    v_mul_u32_u24 v11, 28, v10
    v_sub_u32 v11, v9, v11
    v_subrev_u32 v12, 4, v11
    v_cmp_gt_u32 vcc, 24, v11
    s_nop 1
    v_cndmask_b32 v11, v12, v11, vcc
    v_mul_u32_u24 v10, 3072, v10
    v_lshrrev_b32 v12, 3, v11
    v_lshl_add_u32 v10, v12, 10, v10
    v_and_b32 v11, 7, v11
    v_lshl_add_u32 v10, v11, 4, v10
    v_add_u32 v131, s38, v10

    v_add_u32 v9, s37, v2
    v_add_u32 v9, 256, v9
    v_mul_u32_u24 v10, 2341, v9
    v_lshrrev_b32 v10, 16, v10
    v_mul_u32_u24 v11, 28, v10
    v_sub_u32 v11, v9, v11
    v_subrev_u32 v12, 4, v11
    v_cmp_gt_u32 vcc, 24, v11
    s_nop 1
    v_cndmask_b32 v11, v12, v11, vcc
    v_mul_u32_u24 v10, 3072, v10
    v_lshrrev_b32 v12, 3, v11
    v_lshl_add_u32 v10, v12, 10, v10
    v_and_b32 v11, 7, v11
    v_lshl_add_u32 v10, v11, 4, v10
    v_add_u32 v132, s38, v10

    v_add_u32 v9, s37, v2
    v_add_u32 v9, 320, v9
    v_mul_u32_u24 v10, 2341, v9
    v_lshrrev_b32 v10, 16, v10
    v_mul_u32_u24 v11, 28, v10
    v_sub_u32 v11, v9, v11
    v_subrev_u32 v12, 4, v11
    v_cmp_gt_u32 vcc, 24, v11
    s_nop 1
    v_cndmask_b32 v11, v12, v11, vcc
    v_mul_u32_u24 v10, 3072, v10
    v_lshrrev_b32 v12, 3, v11
    v_lshl_add_u32 v10, v12, 10, v10
    v_and_b32 v11, 7, v11
    v_lshl_add_u32 v10, v11, 4, v10
    v_add_u32 v133, s38, v10

    v_add_u32 v9, s37, v2
    v_add_u32 v9, 384, v9
    v_mul_u32_u24 v10, 2341, v9
    v_lshrrev_b32 v10, 16, v10
    v_mul_u32_u24 v11, 28, v10
    v_sub_u32 v11, v9, v11
    v_subrev_u32 v12, 4, v11
    v_cmp_gt_u32 vcc, 24, v11
    s_nop 1
    v_cndmask_b32 v11, v12, v11, vcc
    v_mul_u32_u24 v10, 3072, v10
    v_lshrrev_b32 v12, 3, v11
    v_lshl_add_u32 v10, v12, 10, v10
    v_and_b32 v11, 7, v11
    v_lshl_add_u32 v10, v11, 4, v10
    v_add_u32 v134, s38, v10

    s_mul_i32 s37, s30, 7168
    s_mov_b32 s39, 0
    s_add_u32 s38, s37, 66560
    s_mov_b32 m0, s38
    s_nop 0
    buffer_load_dwordx4 v128, s[16:19], s39 offen lds
    s_add_u32 s38, s37, 67584
    s_mov_b32 m0, s38
    s_nop 0
    buffer_load_dwordx4 v129, s[16:19], s39 offen lds
    s_add_u32 s38, s37, 68608
    s_mov_b32 m0, s38
    s_nop 0
    buffer_load_dwordx4 v130, s[16:19], s39 offen lds
    s_add_u32 s38, s37, 69632
    s_mov_b32 m0, s38
    s_nop 0
    buffer_load_dwordx4 v131, s[16:19], s39 offen lds
    s_add_u32 s38, s37, 70656
    s_mov_b32 m0, s38
    s_nop 0
    buffer_load_dwordx4 v132, s[16:19], s39 offen lds
    s_add_u32 s38, s37, 71680
    s_mov_b32 m0, s38
    s_nop 0
    buffer_load_dwordx4 v133, s[16:19], s39 offen lds
    s_add_u32 s38, s37, 72704
    s_mov_b32 m0, s38
    s_nop 0
    buffer_load_dwordx4 v134, s[16:19], s39 offen lds
    s_mov_b32 s39, 196608
    s_add_u32 s38, s37, 95232
    s_mov_b32 m0, s38
    s_nop 0
    buffer_load_dwordx4 v128, s[16:19], s39 offen lds
    s_add_u32 s38, s37, 96256
    s_mov_b32 m0, s38
    s_nop 0
    buffer_load_dwordx4 v129, s[16:19], s39 offen lds
    s_add_u32 s38, s37, 97280
    s_mov_b32 m0, s38
    s_nop 0
    buffer_load_dwordx4 v130, s[16:19], s39 offen lds
    s_add_u32 s38, s37, 98304
    s_mov_b32 m0, s38
    s_nop 0
    buffer_load_dwordx4 v131, s[16:19], s39 offen lds
    s_add_u32 s38, s37, 99328
    s_mov_b32 m0, s38
    s_nop 0
    buffer_load_dwordx4 v132, s[16:19], s39 offen lds
    s_add_u32 s38, s37, 100352
    s_mov_b32 m0, s38
    s_nop 0
    buffer_load_dwordx4 v133, s[16:19], s39 offen lds
    s_add_u32 s38, s37, 101376
    s_mov_b32 m0, s38
    s_nop 0
    buffer_load_dwordx4 v134, s[16:19], s39 offen lds
    s_mov_b32 s39, 393216
    s_add_u32 s38, s37, 123904
    s_mov_b32 m0, s38
    s_nop 0
    buffer_load_dwordx4 v128, s[16:19], s39 offen lds
    s_add_u32 s38, s37, 124928
    s_mov_b32 m0, s38
    s_nop 0
    buffer_load_dwordx4 v129, s[16:19], s39 offen lds
    s_add_u32 s38, s37, 125952
    s_mov_b32 m0, s38
    s_nop 0
    buffer_load_dwordx4 v130, s[16:19], s39 offen lds
    s_add_u32 s38, s37, 126976
    s_mov_b32 m0, s38
    s_nop 0
    buffer_load_dwordx4 v131, s[16:19], s39 offen lds
    s_add_u32 s38, s37, 128000
    s_mov_b32 m0, s38
    s_nop 0
    buffer_load_dwordx4 v132, s[16:19], s39 offen lds
    s_add_u32 s38, s37, 129024
    s_mov_b32 m0, s38
    s_nop 0
    buffer_load_dwordx4 v133, s[16:19], s39 offen lds
    s_add_u32 s38, s37, 130048
    s_mov_b32 m0, s38
    s_nop 0
    buffer_load_dwordx4 v134, s[16:19], s39 offen lds
    v_and_b32 v13, 31, v2
    s_and_b32 s36, s30, 1
    s_lshl_b32 s36, s36, 5
    v_add_u32 v13, s36, v13
    v_mul_u32_u24 v13, 1040, v13
    v_lshrrev_b32 v14, 5, v2
    v_lshl_add_u32 v13, v14, 4, v13

    v_lshrrev_b32 v14, 5, v2
    v_lshlrev_b32 v14, 3, v14
    v_bfe_u32 v15, v2, 2, 2
    v_add_u32 v14, v14, v15
    v_mul_u32_u24 v14, 448, v14
    v_bfe_u32 v15, v2, 4, 1
    v_lshlrev_b32 v15, 5, v15
    v_add_u32 v14, v14, v15
    v_and_b32 v15, 3, v2
    v_lshl_add_u32 v14, v15, 3, v14
    s_lshr_b32 s36, s30, 1
    s_lshl_b32 s36, s36, 6
    v_add_u32 v14, s36, v14
    v_add_u32 v15, 95232, v14
    v_add_u32 v135, 123904, v14
    v_add_u32 v14, 66560, v14

    s_waitcnt vmcnt(33)
    v_dot2_f32_bf16 v152, v64, s40, 0
    v_dot2_f32_bf16 v154, v64, v64, 0
    v_dot2_f32_bf16 v153, v65, s40, 0
    v_dot2_f32_bf16 v155, v65, v65, 0
    v_dot2_f32_bf16 v152, v66, s40, v152
    v_dot2_f32_bf16 v154, v66, v66, v154
    v_dot2_f32_bf16 v153, v67, s40, v153
    v_dot2_f32_bf16 v155, v67, v67, v155
    v_dot2_f32_bf16 v152, v68, s40, v152
    v_dot2_f32_bf16 v154, v68, v68, v154
    v_dot2_f32_bf16 v153, v69, s40, v153
    v_dot2_f32_bf16 v155, v69, v69, v155
    v_dot2_f32_bf16 v152, v70, s40, v152
    v_dot2_f32_bf16 v154, v70, v70, v154
    v_dot2_f32_bf16 v153, v71, s40, v153
    v_dot2_f32_bf16 v155, v71, v71, v155
    v_dot2_f32_bf16 v152, v72, s40, v152
    v_dot2_f32_bf16 v154, v72, v72, v154
    v_dot2_f32_bf16 v153, v73, s40, v153
    v_dot2_f32_bf16 v155, v73, v73, v155
    v_dot2_f32_bf16 v152, v74, s40, v152
    v_dot2_f32_bf16 v154, v74, v74, v154
    v_dot2_f32_bf16 v153, v75, s40, v153
    v_dot2_f32_bf16 v155, v75, v75, v155
    v_dot2_f32_bf16 v152, v76, s40, v152
    v_dot2_f32_bf16 v154, v76, v76, v154
    v_dot2_f32_bf16 v153, v77, s40, v153
    v_dot2_f32_bf16 v155, v77, v77, v155
    v_dot2_f32_bf16 v152, v78, s40, v152
    v_dot2_f32_bf16 v154, v78, v78, v154
    v_dot2_f32_bf16 v153, v79, s40, v153
    v_dot2_f32_bf16 v155, v79, v79, v155
    s_nop 2
    v_add_f32 v152, v152, v153
    v_add_f32 v154, v154, v155
    s_nop 0
    v_add_f32_dpp v152, v152, v152 row_ror:8 row_mask:0xf bank_mask:0xf
    v_add_f32_dpp v154, v154, v154 row_ror:8 row_mask:0xf bank_mask:0xf
    s_nop 0
    v_add_f32_dpp v152, v152, v152 row_ror:4 row_mask:0xf bank_mask:0xf
    v_add_f32_dpp v154, v154, v154 row_ror:4 row_mask:0xf bank_mask:0xf
    s_nop 0
    v_add_f32_dpp v152, v152, v152 row_ror:2 row_mask:0xf bank_mask:0xf
    v_add_f32_dpp v154, v154, v154 row_ror:2 row_mask:0xf bank_mask:0xf
    s_nop 0
    v_add_f32_dpp v152, v152, v152 row_ror:1 row_mask:0xf bank_mask:0xf
    v_add_f32_dpp v154, v154, v154 row_ror:1 row_mask:0xf bank_mask:0xf
    v_mul_f32 v156, 0x3b000000, v152
    v_mul_f32 v157, 0x3b000000, v154
    v_fma_f32 v157, -v156, v156, v157
    v_max_f32 v157, 0, v157
    v_cvt_pk_bf16_f32 v156, 0, v156
    v_cvt_pk_bf16_f32 v157, 0, v157
    v_add_f32 v157, 0x3727c5ac, v157
    v_cvt_pk_bf16_f32 v157, 0, v157
    v_sqrt_f32 v157, v157
    v_sub_f32 v159, 0, v156
    v_cvt_pk_bf16_f32 v157, 0, v157
    v_rcp_f32 v158, v157

    v_dot2_f32_bf16 v16, v64, s41, v159
    v_dot2_f32_bf16 v17, v64, s42, v159
    v_dot2_f32_bf16 v18, v65, s41, v159
    v_dot2_f32_bf16 v19, v65, s42, v159
    v_dot2_f32_bf16 v20, v66, s41, v159
    v_dot2_f32_bf16 v21, v66, s42, v159
    v_dot2_f32_bf16 v22, v67, s41, v159
    v_dot2_f32_bf16 v23, v67, s42, v159
    v_dot2_f32_bf16 v24, v68, s41, v159
    v_dot2_f32_bf16 v25, v68, s42, v159
    v_dot2_f32_bf16 v26, v69, s41, v159
    v_dot2_f32_bf16 v27, v69, s42, v159
    v_dot2_f32_bf16 v28, v70, s41, v159
    v_dot2_f32_bf16 v29, v70, s42, v159
    v_dot2_f32_bf16 v30, v71, s41, v159
    v_dot2_f32_bf16 v31, v71, s42, v159
    v_dot2_f32_bf16 v32, v72, s41, v159
    v_dot2_f32_bf16 v33, v72, s42, v159
    v_dot2_f32_bf16 v34, v73, s41, v159
    v_dot2_f32_bf16 v35, v73, s42, v159
    v_dot2_f32_bf16 v36, v74, s41, v159
    v_dot2_f32_bf16 v37, v74, s42, v159
    v_dot2_f32_bf16 v38, v75, s41, v159
    v_dot2_f32_bf16 v39, v75, s42, v159
    v_dot2_f32_bf16 v40, v76, s41, v159
    v_dot2_f32_bf16 v41, v76, s42, v159
    v_dot2_f32_bf16 v42, v77, s41, v159
    v_dot2_f32_bf16 v43, v77, s42, v159
    v_dot2_f32_bf16 v44, v78, s41, v159
    v_dot2_f32_bf16 v45, v78, s42, v159
    v_dot2_f32_bf16 v46, v79, s41, v159
    v_dot2_f32_bf16 v47, v79, s42, v159
    v_cvt_pk_bf16_f32 v16, 0, v16
    v_cvt_pk_bf16_f32 v17, 0, v17
    v_cvt_pk_bf16_f32 v18, 0, v18
    v_cvt_pk_bf16_f32 v19, 0, v19
    v_cvt_pk_bf16_f32 v20, 0, v20
    v_cvt_pk_bf16_f32 v21, 0, v21
    v_cvt_pk_bf16_f32 v22, 0, v22
    v_cvt_pk_bf16_f32 v23, 0, v23
    v_cvt_pk_bf16_f32 v24, 0, v24
    v_cvt_pk_bf16_f32 v25, 0, v25
    v_cvt_pk_bf16_f32 v26, 0, v26
    v_cvt_pk_bf16_f32 v27, 0, v27
    v_cvt_pk_bf16_f32 v28, 0, v28
    v_cvt_pk_bf16_f32 v29, 0, v29
    v_cvt_pk_bf16_f32 v30, 0, v30
    v_cvt_pk_bf16_f32 v31, 0, v31
    v_cvt_pk_bf16_f32 v32, 0, v32
    v_cvt_pk_bf16_f32 v33, 0, v33
    v_cvt_pk_bf16_f32 v34, 0, v34
    v_cvt_pk_bf16_f32 v35, 0, v35
    v_cvt_pk_bf16_f32 v36, 0, v36
    v_cvt_pk_bf16_f32 v37, 0, v37
    v_cvt_pk_bf16_f32 v38, 0, v38
    v_cvt_pk_bf16_f32 v39, 0, v39
    v_cvt_pk_bf16_f32 v40, 0, v40
    v_cvt_pk_bf16_f32 v41, 0, v41
    v_cvt_pk_bf16_f32 v42, 0, v42
    v_cvt_pk_bf16_f32 v43, 0, v43
    v_cvt_pk_bf16_f32 v44, 0, v44
    v_cvt_pk_bf16_f32 v45, 0, v45
    v_cvt_pk_bf16_f32 v46, 0, v46
    v_cvt_pk_bf16_f32 v47, 0, v47
    v_mul_f32 v16, v16, v158
    v_mul_f32 v17, v17, v158
    v_mul_f32 v18, v18, v158
    v_mul_f32 v19, v19, v158
    v_mul_f32 v20, v20, v158
    v_mul_f32 v21, v21, v158
    v_mul_f32 v22, v22, v158
    v_mul_f32 v23, v23, v158
    v_mul_f32 v24, v24, v158
    v_mul_f32 v25, v25, v158
    v_mul_f32 v26, v26, v158
    v_mul_f32 v27, v27, v158
    v_mul_f32 v28, v28, v158
    v_mul_f32 v29, v29, v158
    v_mul_f32 v30, v30, v158
    v_mul_f32 v31, v31, v158
    v_mul_f32 v32, v32, v158
    v_mul_f32 v33, v33, v158
    v_mul_f32 v34, v34, v158
    v_mul_f32 v35, v35, v158
    v_mul_f32 v36, v36, v158
    v_mul_f32 v37, v37, v158
    v_mul_f32 v38, v38, v158
    v_mul_f32 v39, v39, v158
    v_mul_f32 v40, v40, v158
    v_mul_f32 v41, v41, v158
    v_mul_f32 v42, v42, v158
    v_mul_f32 v43, v43, v158
    v_mul_f32 v44, v44, v158
    v_mul_f32 v45, v45, v158
    v_mul_f32 v46, v46, v158
    v_mul_f32 v47, v47, v158
    v_cvt_pk_bf16_f32 v64, v16, v17
    v_cvt_pk_bf16_f32 v65, v18, v19
    v_cvt_pk_bf16_f32 v66, v20, v21
    v_cvt_pk_bf16_f32 v67, v22, v23
    v_cvt_pk_bf16_f32 v68, v24, v25
    v_cvt_pk_bf16_f32 v69, v26, v27
    v_cvt_pk_bf16_f32 v70, v28, v29
    v_cvt_pk_bf16_f32 v71, v30, v31
    v_cvt_pk_bf16_f32 v72, v32, v33
    v_cvt_pk_bf16_f32 v73, v34, v35
    v_cvt_pk_bf16_f32 v74, v36, v37
    v_cvt_pk_bf16_f32 v75, v38, v39
    v_cvt_pk_bf16_f32 v76, v40, v41
    v_cvt_pk_bf16_f32 v77, v42, v43
    v_cvt_pk_bf16_f32 v78, v44, v45
    v_cvt_pk_bf16_f32 v79, v46, v47
    ds_write_b128 v6, v[64:67] offset:0
    ds_write_b128 v6, v[68:71] offset:256
    ds_write_b128 v6, v[72:75] offset:512
    ds_write_b128 v6, v[76:79] offset:768
    v_dot2_f32_bf16 v152, v64, v48, 0
    v_dot2_f32_bf16 v153, v65, v49, 0
    v_dot2_f32_bf16 v152, v66, v50, v152
    v_dot2_f32_bf16 v153, v67, v51, v153
    v_dot2_f32_bf16 v152, v68, v52, v152
    v_dot2_f32_bf16 v153, v69, v53, v153
    v_dot2_f32_bf16 v152, v70, v54, v152
    v_dot2_f32_bf16 v153, v71, v55, v153
    v_dot2_f32_bf16 v152, v72, v56, v152
    v_dot2_f32_bf16 v153, v73, v57, v153
    v_dot2_f32_bf16 v152, v74, v58, v152
    v_dot2_f32_bf16 v153, v75, v59, v153
    v_dot2_f32_bf16 v152, v76, v60, v152
    v_dot2_f32_bf16 v153, v77, v61, v153
    v_dot2_f32_bf16 v152, v78, v62, v152
    v_dot2_f32_bf16 v153, v79, v63, v153
    s_nop 2
    v_add_f32 v152, v152, v153
    s_nop 1
    v_add_f32_dpp v152, v152, v152 row_ror:8 row_mask:0xf bank_mask:0xf
    s_nop 1
    v_add_f32_dpp v152, v152, v152 row_ror:4 row_mask:0xf bank_mask:0xf
    s_nop 1
    v_add_f32_dpp v152, v152, v152 row_ror:2 row_mask:0xf bank_mask:0xf
    s_nop 1
    v_add_f32_dpp v152, v152, v152 row_ror:1 row_mask:0xf bank_mask:0xf
    v_cvt_pk_bf16_f32 v152, 0, v152
    v_ashrrev_i32 v153, 31, v152
    v_or_b32 v153, 0x80000000, v153
    v_xor_b32 v152, v152, v153
    v_and_b32 v152, 0xffff0000, v152
    v_lshrrev_b32 v153, 2, v8
    v_sub_u32 v153, 2047, v153
    v_or_b32 v152, v152, v153

    s_cmp_lg_u32 s29, 0
    s_cbranch_scc1 k1_skipkey_1
    v_cmp_eq_u32 vcc, 0, v4
    s_and_saveexec_b64 s[44:45], vcc
    s_mov_b32 s36, 10485760
    buffer_store_dword v152, v8, s[24:27], s36 offen
    s_mov_b64 exec, s[44:45]

k1_skipkey_1:
    s_lshl_b32 s36, s30, 1
    s_add_u32 s36, s36, 0
    s_cmp_lg_u32 s29, s36
    s_cbranch_scc1 k1_skipxn_2

    buffer_store_dwordx4 v[64:67], v5, s[24:27], s32 offen offset:0
    buffer_store_dwordx4 v[68:71], v5, s[24:27], s32 offen offset:256
    buffer_store_dwordx4 v[72:75], v5, s[24:27], s32 offen offset:512
    buffer_store_dwordx4 v[76:79], v5, s[24:27], s32 offen offset:768
k1_skipxn_2:
    s_waitcnt vmcnt(29)
    v_dot2_f32_bf16 v152, v80, s40, 0
    v_dot2_f32_bf16 v154, v80, v80, 0
    v_dot2_f32_bf16 v153, v81, s40, 0
    v_dot2_f32_bf16 v155, v81, v81, 0
    v_dot2_f32_bf16 v152, v82, s40, v152
    v_dot2_f32_bf16 v154, v82, v82, v154
    v_dot2_f32_bf16 v153, v83, s40, v153
    v_dot2_f32_bf16 v155, v83, v83, v155
    v_dot2_f32_bf16 v152, v84, s40, v152
    v_dot2_f32_bf16 v154, v84, v84, v154
    v_dot2_f32_bf16 v153, v85, s40, v153
    v_dot2_f32_bf16 v155, v85, v85, v155
    v_dot2_f32_bf16 v152, v86, s40, v152
    v_dot2_f32_bf16 v154, v86, v86, v154
    v_dot2_f32_bf16 v153, v87, s40, v153
    v_dot2_f32_bf16 v155, v87, v87, v155
    v_dot2_f32_bf16 v152, v88, s40, v152
    v_dot2_f32_bf16 v154, v88, v88, v154
    v_dot2_f32_bf16 v153, v89, s40, v153
    v_dot2_f32_bf16 v155, v89, v89, v155
    v_dot2_f32_bf16 v152, v90, s40, v152
    v_dot2_f32_bf16 v154, v90, v90, v154
    v_dot2_f32_bf16 v153, v91, s40, v153
    v_dot2_f32_bf16 v155, v91, v91, v155
    v_dot2_f32_bf16 v152, v92, s40, v152
    v_dot2_f32_bf16 v154, v92, v92, v154
    v_dot2_f32_bf16 v153, v93, s40, v153
    v_dot2_f32_bf16 v155, v93, v93, v155
    v_dot2_f32_bf16 v152, v94, s40, v152
    v_dot2_f32_bf16 v154, v94, v94, v154
    v_dot2_f32_bf16 v153, v95, s40, v153
    v_dot2_f32_bf16 v155, v95, v95, v155
    s_nop 2
    v_add_f32 v152, v152, v153
    v_add_f32 v154, v154, v155
    s_nop 0
    v_add_f32_dpp v152, v152, v152 row_ror:8 row_mask:0xf bank_mask:0xf
    v_add_f32_dpp v154, v154, v154 row_ror:8 row_mask:0xf bank_mask:0xf
    s_nop 0
    v_add_f32_dpp v152, v152, v152 row_ror:4 row_mask:0xf bank_mask:0xf
    v_add_f32_dpp v154, v154, v154 row_ror:4 row_mask:0xf bank_mask:0xf
    s_nop 0
    v_add_f32_dpp v152, v152, v152 row_ror:2 row_mask:0xf bank_mask:0xf
    v_add_f32_dpp v154, v154, v154 row_ror:2 row_mask:0xf bank_mask:0xf
    s_nop 0
    v_add_f32_dpp v152, v152, v152 row_ror:1 row_mask:0xf bank_mask:0xf
    v_add_f32_dpp v154, v154, v154 row_ror:1 row_mask:0xf bank_mask:0xf
    v_mul_f32 v156, 0x3b000000, v152
    v_mul_f32 v157, 0x3b000000, v154
    v_fma_f32 v157, -v156, v156, v157
    v_max_f32 v157, 0, v157
    v_cvt_pk_bf16_f32 v156, 0, v156
    v_cvt_pk_bf16_f32 v157, 0, v157
    v_add_f32 v157, 0x3727c5ac, v157
    v_cvt_pk_bf16_f32 v157, 0, v157
    v_sqrt_f32 v157, v157
    v_sub_f32 v159, 0, v156
    v_cvt_pk_bf16_f32 v157, 0, v157
    v_rcp_f32 v158, v157

    v_dot2_f32_bf16 v16, v80, s41, v159
    v_dot2_f32_bf16 v17, v80, s42, v159
    v_dot2_f32_bf16 v18, v81, s41, v159
    v_dot2_f32_bf16 v19, v81, s42, v159
    v_dot2_f32_bf16 v20, v82, s41, v159
    v_dot2_f32_bf16 v21, v82, s42, v159
    v_dot2_f32_bf16 v22, v83, s41, v159
    v_dot2_f32_bf16 v23, v83, s42, v159
    v_dot2_f32_bf16 v24, v84, s41, v159
    v_dot2_f32_bf16 v25, v84, s42, v159
    v_dot2_f32_bf16 v26, v85, s41, v159
    v_dot2_f32_bf16 v27, v85, s42, v159
    v_dot2_f32_bf16 v28, v86, s41, v159
    v_dot2_f32_bf16 v29, v86, s42, v159
    v_dot2_f32_bf16 v30, v87, s41, v159
    v_dot2_f32_bf16 v31, v87, s42, v159
    v_dot2_f32_bf16 v32, v88, s41, v159
    v_dot2_f32_bf16 v33, v88, s42, v159
    v_dot2_f32_bf16 v34, v89, s41, v159
    v_dot2_f32_bf16 v35, v89, s42, v159
    v_dot2_f32_bf16 v36, v90, s41, v159
    v_dot2_f32_bf16 v37, v90, s42, v159
    v_dot2_f32_bf16 v38, v91, s41, v159
    v_dot2_f32_bf16 v39, v91, s42, v159
    v_dot2_f32_bf16 v40, v92, s41, v159
    v_dot2_f32_bf16 v41, v92, s42, v159
    v_dot2_f32_bf16 v42, v93, s41, v159
    v_dot2_f32_bf16 v43, v93, s42, v159
    v_dot2_f32_bf16 v44, v94, s41, v159
    v_dot2_f32_bf16 v45, v94, s42, v159
    v_dot2_f32_bf16 v46, v95, s41, v159
    v_dot2_f32_bf16 v47, v95, s42, v159
    v_cvt_pk_bf16_f32 v16, 0, v16
    v_cvt_pk_bf16_f32 v17, 0, v17
    v_cvt_pk_bf16_f32 v18, 0, v18
    v_cvt_pk_bf16_f32 v19, 0, v19
    v_cvt_pk_bf16_f32 v20, 0, v20
    v_cvt_pk_bf16_f32 v21, 0, v21
    v_cvt_pk_bf16_f32 v22, 0, v22
    v_cvt_pk_bf16_f32 v23, 0, v23
    v_cvt_pk_bf16_f32 v24, 0, v24
    v_cvt_pk_bf16_f32 v25, 0, v25
    v_cvt_pk_bf16_f32 v26, 0, v26
    v_cvt_pk_bf16_f32 v27, 0, v27
    v_cvt_pk_bf16_f32 v28, 0, v28
    v_cvt_pk_bf16_f32 v29, 0, v29
    v_cvt_pk_bf16_f32 v30, 0, v30
    v_cvt_pk_bf16_f32 v31, 0, v31
    v_cvt_pk_bf16_f32 v32, 0, v32
    v_cvt_pk_bf16_f32 v33, 0, v33
    v_cvt_pk_bf16_f32 v34, 0, v34
    v_cvt_pk_bf16_f32 v35, 0, v35
    v_cvt_pk_bf16_f32 v36, 0, v36
    v_cvt_pk_bf16_f32 v37, 0, v37
    v_cvt_pk_bf16_f32 v38, 0, v38
    v_cvt_pk_bf16_f32 v39, 0, v39
    v_cvt_pk_bf16_f32 v40, 0, v40
    v_cvt_pk_bf16_f32 v41, 0, v41
    v_cvt_pk_bf16_f32 v42, 0, v42
    v_cvt_pk_bf16_f32 v43, 0, v43
    v_cvt_pk_bf16_f32 v44, 0, v44
    v_cvt_pk_bf16_f32 v45, 0, v45
    v_cvt_pk_bf16_f32 v46, 0, v46
    v_cvt_pk_bf16_f32 v47, 0, v47
    v_mul_f32 v16, v16, v158
    v_mul_f32 v17, v17, v158
    v_mul_f32 v18, v18, v158
    v_mul_f32 v19, v19, v158
    v_mul_f32 v20, v20, v158
    v_mul_f32 v21, v21, v158
    v_mul_f32 v22, v22, v158
    v_mul_f32 v23, v23, v158
    v_mul_f32 v24, v24, v158
    v_mul_f32 v25, v25, v158
    v_mul_f32 v26, v26, v158
    v_mul_f32 v27, v27, v158
    v_mul_f32 v28, v28, v158
    v_mul_f32 v29, v29, v158
    v_mul_f32 v30, v30, v158
    v_mul_f32 v31, v31, v158
    v_mul_f32 v32, v32, v158
    v_mul_f32 v33, v33, v158
    v_mul_f32 v34, v34, v158
    v_mul_f32 v35, v35, v158
    v_mul_f32 v36, v36, v158
    v_mul_f32 v37, v37, v158
    v_mul_f32 v38, v38, v158
    v_mul_f32 v39, v39, v158
    v_mul_f32 v40, v40, v158
    v_mul_f32 v41, v41, v158
    v_mul_f32 v42, v42, v158
    v_mul_f32 v43, v43, v158
    v_mul_f32 v44, v44, v158
    v_mul_f32 v45, v45, v158
    v_mul_f32 v46, v46, v158
    v_mul_f32 v47, v47, v158
    v_cvt_pk_bf16_f32 v80, v16, v17
    v_cvt_pk_bf16_f32 v81, v18, v19
    v_cvt_pk_bf16_f32 v82, v20, v21
    v_cvt_pk_bf16_f32 v83, v22, v23
    v_cvt_pk_bf16_f32 v84, v24, v25
    v_cvt_pk_bf16_f32 v85, v26, v27
    v_cvt_pk_bf16_f32 v86, v28, v29
    v_cvt_pk_bf16_f32 v87, v30, v31
    v_cvt_pk_bf16_f32 v88, v32, v33
    v_cvt_pk_bf16_f32 v89, v34, v35
    v_cvt_pk_bf16_f32 v90, v36, v37
    v_cvt_pk_bf16_f32 v91, v38, v39
    v_cvt_pk_bf16_f32 v92, v40, v41
    v_cvt_pk_bf16_f32 v93, v42, v43
    v_cvt_pk_bf16_f32 v94, v44, v45
    v_cvt_pk_bf16_f32 v95, v46, v47
    ds_write_b128 v6, v[80:83] offset:4160
    ds_write_b128 v6, v[84:87] offset:4416
    ds_write_b128 v6, v[88:91] offset:4672
    ds_write_b128 v6, v[92:95] offset:4928
    v_dot2_f32_bf16 v152, v80, v48, 0
    v_dot2_f32_bf16 v153, v81, v49, 0
    v_dot2_f32_bf16 v152, v82, v50, v152
    v_dot2_f32_bf16 v153, v83, v51, v153
    v_dot2_f32_bf16 v152, v84, v52, v152
    v_dot2_f32_bf16 v153, v85, v53, v153
    v_dot2_f32_bf16 v152, v86, v54, v152
    v_dot2_f32_bf16 v153, v87, v55, v153
    v_dot2_f32_bf16 v152, v88, v56, v152
    v_dot2_f32_bf16 v153, v89, v57, v153
    v_dot2_f32_bf16 v152, v90, v58, v152
    v_dot2_f32_bf16 v153, v91, v59, v153
    v_dot2_f32_bf16 v152, v92, v60, v152
    v_dot2_f32_bf16 v153, v93, v61, v153
    v_dot2_f32_bf16 v152, v94, v62, v152
    v_dot2_f32_bf16 v153, v95, v63, v153
    s_nop 2
    v_add_f32 v152, v152, v153
    s_nop 1
    v_add_f32_dpp v152, v152, v152 row_ror:8 row_mask:0xf bank_mask:0xf
    s_nop 1
    v_add_f32_dpp v152, v152, v152 row_ror:4 row_mask:0xf bank_mask:0xf
    s_nop 1
    v_add_f32_dpp v152, v152, v152 row_ror:2 row_mask:0xf bank_mask:0xf
    s_nop 1
    v_add_f32_dpp v152, v152, v152 row_ror:1 row_mask:0xf bank_mask:0xf
    v_cvt_pk_bf16_f32 v152, 0, v152
    v_ashrrev_i32 v153, 31, v152
    v_or_b32 v153, 0x80000000, v153
    v_xor_b32 v152, v152, v153
    v_and_b32 v152, 0xffff0000, v152
    v_lshrrev_b32 v153, 2, v8
    v_sub_u32 v153, 2043, v153
    v_or_b32 v152, v152, v153

    s_cmp_lg_u32 s29, 0
    s_cbranch_scc1 k1_skipkey_3
    v_cmp_eq_u32 vcc, 0, v4
    s_and_saveexec_b64 s[44:45], vcc
    s_mov_b32 s36, 10485776
    buffer_store_dword v152, v8, s[24:27], s36 offen
    s_mov_b64 exec, s[44:45]

k1_skipkey_3:
    s_lshl_b32 s36, s30, 1
    s_add_u32 s36, s36, 0
    s_cmp_lg_u32 s29, s36
    s_cbranch_scc1 k1_skipxn_4

    buffer_store_dwordx4 v[80:83], v5, s[24:27], s33 offen offset:0
    buffer_store_dwordx4 v[84:87], v5, s[24:27], s33 offen offset:256
    buffer_store_dwordx4 v[88:91], v5, s[24:27], s33 offen offset:512
    buffer_store_dwordx4 v[92:95], v5, s[24:27], s33 offen offset:768
k1_skipxn_4:
    s_waitcnt vmcnt(25)
    v_dot2_f32_bf16 v152, v96, s40, 0
    v_dot2_f32_bf16 v154, v96, v96, 0
    v_dot2_f32_bf16 v153, v97, s40, 0
    v_dot2_f32_bf16 v155, v97, v97, 0
    v_dot2_f32_bf16 v152, v98, s40, v152
    v_dot2_f32_bf16 v154, v98, v98, v154
    v_dot2_f32_bf16 v153, v99, s40, v153
    v_dot2_f32_bf16 v155, v99, v99, v155
    v_dot2_f32_bf16 v152, v100, s40, v152
    v_dot2_f32_bf16 v154, v100, v100, v154
    v_dot2_f32_bf16 v153, v101, s40, v153
    v_dot2_f32_bf16 v155, v101, v101, v155
    v_dot2_f32_bf16 v152, v102, s40, v152
    v_dot2_f32_bf16 v154, v102, v102, v154
    v_dot2_f32_bf16 v153, v103, s40, v153
    v_dot2_f32_bf16 v155, v103, v103, v155
    v_dot2_f32_bf16 v152, v104, s40, v152
    v_dot2_f32_bf16 v154, v104, v104, v154
    v_dot2_f32_bf16 v153, v105, s40, v153
    v_dot2_f32_bf16 v155, v105, v105, v155
    v_dot2_f32_bf16 v152, v106, s40, v152
    v_dot2_f32_bf16 v154, v106, v106, v154
    v_dot2_f32_bf16 v153, v107, s40, v153
    v_dot2_f32_bf16 v155, v107, v107, v155
    v_dot2_f32_bf16 v152, v108, s40, v152
    v_dot2_f32_bf16 v154, v108, v108, v154
    v_dot2_f32_bf16 v153, v109, s40, v153
    v_dot2_f32_bf16 v155, v109, v109, v155
    v_dot2_f32_bf16 v152, v110, s40, v152
    v_dot2_f32_bf16 v154, v110, v110, v154
    v_dot2_f32_bf16 v153, v111, s40, v153
    v_dot2_f32_bf16 v155, v111, v111, v155
    s_nop 2
    v_add_f32 v152, v152, v153
    v_add_f32 v154, v154, v155
    s_nop 0
    v_add_f32_dpp v152, v152, v152 row_ror:8 row_mask:0xf bank_mask:0xf
    v_add_f32_dpp v154, v154, v154 row_ror:8 row_mask:0xf bank_mask:0xf
    s_nop 0
    v_add_f32_dpp v152, v152, v152 row_ror:4 row_mask:0xf bank_mask:0xf
    v_add_f32_dpp v154, v154, v154 row_ror:4 row_mask:0xf bank_mask:0xf
    s_nop 0
    v_add_f32_dpp v152, v152, v152 row_ror:2 row_mask:0xf bank_mask:0xf
    v_add_f32_dpp v154, v154, v154 row_ror:2 row_mask:0xf bank_mask:0xf
    s_nop 0
    v_add_f32_dpp v152, v152, v152 row_ror:1 row_mask:0xf bank_mask:0xf
    v_add_f32_dpp v154, v154, v154 row_ror:1 row_mask:0xf bank_mask:0xf
    v_mul_f32 v156, 0x3b000000, v152
    v_mul_f32 v157, 0x3b000000, v154
    v_fma_f32 v157, -v156, v156, v157
    v_max_f32 v157, 0, v157
    v_cvt_pk_bf16_f32 v156, 0, v156
    v_cvt_pk_bf16_f32 v157, 0, v157
    v_add_f32 v157, 0x3727c5ac, v157
    v_cvt_pk_bf16_f32 v157, 0, v157
    v_sqrt_f32 v157, v157
    v_sub_f32 v159, 0, v156
    v_cvt_pk_bf16_f32 v157, 0, v157
    v_rcp_f32 v158, v157

    v_dot2_f32_bf16 v16, v96, s41, v159
    v_dot2_f32_bf16 v17, v96, s42, v159
    v_dot2_f32_bf16 v18, v97, s41, v159
    v_dot2_f32_bf16 v19, v97, s42, v159
    v_dot2_f32_bf16 v20, v98, s41, v159
    v_dot2_f32_bf16 v21, v98, s42, v159
    v_dot2_f32_bf16 v22, v99, s41, v159
    v_dot2_f32_bf16 v23, v99, s42, v159
    v_dot2_f32_bf16 v24, v100, s41, v159
    v_dot2_f32_bf16 v25, v100, s42, v159
    v_dot2_f32_bf16 v26, v101, s41, v159
    v_dot2_f32_bf16 v27, v101, s42, v159
    v_dot2_f32_bf16 v28, v102, s41, v159
    v_dot2_f32_bf16 v29, v102, s42, v159
    v_dot2_f32_bf16 v30, v103, s41, v159
    v_dot2_f32_bf16 v31, v103, s42, v159
    v_dot2_f32_bf16 v32, v104, s41, v159
    v_dot2_f32_bf16 v33, v104, s42, v159
    v_dot2_f32_bf16 v34, v105, s41, v159
    v_dot2_f32_bf16 v35, v105, s42, v159
    v_dot2_f32_bf16 v36, v106, s41, v159
    v_dot2_f32_bf16 v37, v106, s42, v159
    v_dot2_f32_bf16 v38, v107, s41, v159
    v_dot2_f32_bf16 v39, v107, s42, v159
    v_dot2_f32_bf16 v40, v108, s41, v159
    v_dot2_f32_bf16 v41, v108, s42, v159
    v_dot2_f32_bf16 v42, v109, s41, v159
    v_dot2_f32_bf16 v43, v109, s42, v159
    v_dot2_f32_bf16 v44, v110, s41, v159
    v_dot2_f32_bf16 v45, v110, s42, v159
    v_dot2_f32_bf16 v46, v111, s41, v159
    v_dot2_f32_bf16 v47, v111, s42, v159
    v_cvt_pk_bf16_f32 v16, 0, v16
    v_cvt_pk_bf16_f32 v17, 0, v17
    v_cvt_pk_bf16_f32 v18, 0, v18
    v_cvt_pk_bf16_f32 v19, 0, v19
    v_cvt_pk_bf16_f32 v20, 0, v20
    v_cvt_pk_bf16_f32 v21, 0, v21
    v_cvt_pk_bf16_f32 v22, 0, v22
    v_cvt_pk_bf16_f32 v23, 0, v23
    v_cvt_pk_bf16_f32 v24, 0, v24
    v_cvt_pk_bf16_f32 v25, 0, v25
    v_cvt_pk_bf16_f32 v26, 0, v26
    v_cvt_pk_bf16_f32 v27, 0, v27
    v_cvt_pk_bf16_f32 v28, 0, v28
    v_cvt_pk_bf16_f32 v29, 0, v29
    v_cvt_pk_bf16_f32 v30, 0, v30
    v_cvt_pk_bf16_f32 v31, 0, v31
    v_cvt_pk_bf16_f32 v32, 0, v32
    v_cvt_pk_bf16_f32 v33, 0, v33
    v_cvt_pk_bf16_f32 v34, 0, v34
    v_cvt_pk_bf16_f32 v35, 0, v35
    v_cvt_pk_bf16_f32 v36, 0, v36
    v_cvt_pk_bf16_f32 v37, 0, v37
    v_cvt_pk_bf16_f32 v38, 0, v38
    v_cvt_pk_bf16_f32 v39, 0, v39
    v_cvt_pk_bf16_f32 v40, 0, v40
    v_cvt_pk_bf16_f32 v41, 0, v41
    v_cvt_pk_bf16_f32 v42, 0, v42
    v_cvt_pk_bf16_f32 v43, 0, v43
    v_cvt_pk_bf16_f32 v44, 0, v44
    v_cvt_pk_bf16_f32 v45, 0, v45
    v_cvt_pk_bf16_f32 v46, 0, v46
    v_cvt_pk_bf16_f32 v47, 0, v47
    v_mul_f32 v16, v16, v158
    v_mul_f32 v17, v17, v158
    v_mul_f32 v18, v18, v158
    v_mul_f32 v19, v19, v158
    v_mul_f32 v20, v20, v158
    v_mul_f32 v21, v21, v158
    v_mul_f32 v22, v22, v158
    v_mul_f32 v23, v23, v158
    v_mul_f32 v24, v24, v158
    v_mul_f32 v25, v25, v158
    v_mul_f32 v26, v26, v158
    v_mul_f32 v27, v27, v158
    v_mul_f32 v28, v28, v158
    v_mul_f32 v29, v29, v158
    v_mul_f32 v30, v30, v158
    v_mul_f32 v31, v31, v158
    v_mul_f32 v32, v32, v158
    v_mul_f32 v33, v33, v158
    v_mul_f32 v34, v34, v158
    v_mul_f32 v35, v35, v158
    v_mul_f32 v36, v36, v158
    v_mul_f32 v37, v37, v158
    v_mul_f32 v38, v38, v158
    v_mul_f32 v39, v39, v158
    v_mul_f32 v40, v40, v158
    v_mul_f32 v41, v41, v158
    v_mul_f32 v42, v42, v158
    v_mul_f32 v43, v43, v158
    v_mul_f32 v44, v44, v158
    v_mul_f32 v45, v45, v158
    v_mul_f32 v46, v46, v158
    v_mul_f32 v47, v47, v158
    v_cvt_pk_bf16_f32 v96, v16, v17
    v_cvt_pk_bf16_f32 v97, v18, v19
    v_cvt_pk_bf16_f32 v98, v20, v21
    v_cvt_pk_bf16_f32 v99, v22, v23
    v_cvt_pk_bf16_f32 v100, v24, v25
    v_cvt_pk_bf16_f32 v101, v26, v27
    v_cvt_pk_bf16_f32 v102, v28, v29
    v_cvt_pk_bf16_f32 v103, v30, v31
    v_cvt_pk_bf16_f32 v104, v32, v33
    v_cvt_pk_bf16_f32 v105, v34, v35
    v_cvt_pk_bf16_f32 v106, v36, v37
    v_cvt_pk_bf16_f32 v107, v38, v39
    v_cvt_pk_bf16_f32 v108, v40, v41
    v_cvt_pk_bf16_f32 v109, v42, v43
    v_cvt_pk_bf16_f32 v110, v44, v45
    v_cvt_pk_bf16_f32 v111, v46, v47
    ds_write_b128 v6, v[96:99] offset:8320
    ds_write_b128 v6, v[100:103] offset:8576
    ds_write_b128 v6, v[104:107] offset:8832
    ds_write_b128 v6, v[108:111] offset:9088
    v_dot2_f32_bf16 v152, v96, v48, 0
    v_dot2_f32_bf16 v153, v97, v49, 0
    v_dot2_f32_bf16 v152, v98, v50, v152
    v_dot2_f32_bf16 v153, v99, v51, v153
    v_dot2_f32_bf16 v152, v100, v52, v152
    v_dot2_f32_bf16 v153, v101, v53, v153
    v_dot2_f32_bf16 v152, v102, v54, v152
    v_dot2_f32_bf16 v153, v103, v55, v153
    v_dot2_f32_bf16 v152, v104, v56, v152
    v_dot2_f32_bf16 v153, v105, v57, v153
    v_dot2_f32_bf16 v152, v106, v58, v152
    v_dot2_f32_bf16 v153, v107, v59, v153
    v_dot2_f32_bf16 v152, v108, v60, v152
    v_dot2_f32_bf16 v153, v109, v61, v153
    v_dot2_f32_bf16 v152, v110, v62, v152
    v_dot2_f32_bf16 v153, v111, v63, v153
    s_nop 2
    v_add_f32 v152, v152, v153
    s_nop 1
    v_add_f32_dpp v152, v152, v152 row_ror:8 row_mask:0xf bank_mask:0xf
    s_nop 1
    v_add_f32_dpp v152, v152, v152 row_ror:4 row_mask:0xf bank_mask:0xf
    s_nop 1
    v_add_f32_dpp v152, v152, v152 row_ror:2 row_mask:0xf bank_mask:0xf
    s_nop 1
    v_add_f32_dpp v152, v152, v152 row_ror:1 row_mask:0xf bank_mask:0xf
    v_cvt_pk_bf16_f32 v152, 0, v152
    v_ashrrev_i32 v153, 31, v152
    v_or_b32 v153, 0x80000000, v153
    v_xor_b32 v152, v152, v153
    v_and_b32 v152, 0xffff0000, v152
    v_lshrrev_b32 v153, 2, v8
    v_sub_u32 v153, 2039, v153
    v_or_b32 v152, v152, v153

    s_cmp_lg_u32 s29, 0
    s_cbranch_scc1 k1_skipkey_5
    v_cmp_eq_u32 vcc, 0, v4
    s_and_saveexec_b64 s[44:45], vcc
    s_mov_b32 s36, 10485792
    buffer_store_dword v152, v8, s[24:27], s36 offen
    s_mov_b64 exec, s[44:45]

k1_skipkey_5:
    s_lshl_b32 s36, s30, 1
    s_add_u32 s36, s36, 1
    s_cmp_lg_u32 s29, s36
    s_cbranch_scc1 k1_skipxn_6

    buffer_store_dwordx4 v[96:99], v5, s[24:27], s34 offen offset:0
    buffer_store_dwordx4 v[100:103], v5, s[24:27], s34 offen offset:256
    buffer_store_dwordx4 v[104:107], v5, s[24:27], s34 offen offset:512
    buffer_store_dwordx4 v[108:111], v5, s[24:27], s34 offen offset:768
k1_skipxn_6:
    s_waitcnt vmcnt(21)
    v_dot2_f32_bf16 v152, v112, s40, 0
    v_dot2_f32_bf16 v154, v112, v112, 0
    v_dot2_f32_bf16 v153, v113, s40, 0
    v_dot2_f32_bf16 v155, v113, v113, 0
    v_dot2_f32_bf16 v152, v114, s40, v152
    v_dot2_f32_bf16 v154, v114, v114, v154
    v_dot2_f32_bf16 v153, v115, s40, v153
    v_dot2_f32_bf16 v155, v115, v115, v155
    v_dot2_f32_bf16 v152, v116, s40, v152
    v_dot2_f32_bf16 v154, v116, v116, v154
    v_dot2_f32_bf16 v153, v117, s40, v153
    v_dot2_f32_bf16 v155, v117, v117, v155
    v_dot2_f32_bf16 v152, v118, s40, v152
    v_dot2_f32_bf16 v154, v118, v118, v154
    v_dot2_f32_bf16 v153, v119, s40, v153
    v_dot2_f32_bf16 v155, v119, v119, v155
    v_dot2_f32_bf16 v152, v120, s40, v152
    v_dot2_f32_bf16 v154, v120, v120, v154
    v_dot2_f32_bf16 v153, v121, s40, v153
    v_dot2_f32_bf16 v155, v121, v121, v155
    v_dot2_f32_bf16 v152, v122, s40, v152
    v_dot2_f32_bf16 v154, v122, v122, v154
    v_dot2_f32_bf16 v153, v123, s40, v153
    v_dot2_f32_bf16 v155, v123, v123, v155
    v_dot2_f32_bf16 v152, v124, s40, v152
    v_dot2_f32_bf16 v154, v124, v124, v154
    v_dot2_f32_bf16 v153, v125, s40, v153
    v_dot2_f32_bf16 v155, v125, v125, v155
    v_dot2_f32_bf16 v152, v126, s40, v152
    v_dot2_f32_bf16 v154, v126, v126, v154
    v_dot2_f32_bf16 v153, v127, s40, v153
    v_dot2_f32_bf16 v155, v127, v127, v155
    s_nop 2
    v_add_f32 v152, v152, v153
    v_add_f32 v154, v154, v155
    s_nop 0
    v_add_f32_dpp v152, v152, v152 row_ror:8 row_mask:0xf bank_mask:0xf
    v_add_f32_dpp v154, v154, v154 row_ror:8 row_mask:0xf bank_mask:0xf
    s_nop 0
    v_add_f32_dpp v152, v152, v152 row_ror:4 row_mask:0xf bank_mask:0xf
    v_add_f32_dpp v154, v154, v154 row_ror:4 row_mask:0xf bank_mask:0xf
    s_nop 0
    v_add_f32_dpp v152, v152, v152 row_ror:2 row_mask:0xf bank_mask:0xf
    v_add_f32_dpp v154, v154, v154 row_ror:2 row_mask:0xf bank_mask:0xf
    s_nop 0
    v_add_f32_dpp v152, v152, v152 row_ror:1 row_mask:0xf bank_mask:0xf
    v_add_f32_dpp v154, v154, v154 row_ror:1 row_mask:0xf bank_mask:0xf
    v_mul_f32 v156, 0x3b000000, v152
    v_mul_f32 v157, 0x3b000000, v154
    v_fma_f32 v157, -v156, v156, v157
    v_max_f32 v157, 0, v157
    v_cvt_pk_bf16_f32 v156, 0, v156
    v_cvt_pk_bf16_f32 v157, 0, v157
    v_add_f32 v157, 0x3727c5ac, v157
    v_cvt_pk_bf16_f32 v157, 0, v157
    v_sqrt_f32 v157, v157
    v_sub_f32 v159, 0, v156
    v_cvt_pk_bf16_f32 v157, 0, v157
    v_rcp_f32 v158, v157

    v_dot2_f32_bf16 v16, v112, s41, v159
    v_dot2_f32_bf16 v17, v112, s42, v159
    v_dot2_f32_bf16 v18, v113, s41, v159
    v_dot2_f32_bf16 v19, v113, s42, v159
    v_dot2_f32_bf16 v20, v114, s41, v159
    v_dot2_f32_bf16 v21, v114, s42, v159
    v_dot2_f32_bf16 v22, v115, s41, v159
    v_dot2_f32_bf16 v23, v115, s42, v159
    v_dot2_f32_bf16 v24, v116, s41, v159
    v_dot2_f32_bf16 v25, v116, s42, v159
    v_dot2_f32_bf16 v26, v117, s41, v159
    v_dot2_f32_bf16 v27, v117, s42, v159
    v_dot2_f32_bf16 v28, v118, s41, v159
    v_dot2_f32_bf16 v29, v118, s42, v159
    v_dot2_f32_bf16 v30, v119, s41, v159
    v_dot2_f32_bf16 v31, v119, s42, v159
    v_dot2_f32_bf16 v32, v120, s41, v159
    v_dot2_f32_bf16 v33, v120, s42, v159
    v_dot2_f32_bf16 v34, v121, s41, v159
    v_dot2_f32_bf16 v35, v121, s42, v159
    v_dot2_f32_bf16 v36, v122, s41, v159
    v_dot2_f32_bf16 v37, v122, s42, v159
    v_dot2_f32_bf16 v38, v123, s41, v159
    v_dot2_f32_bf16 v39, v123, s42, v159
    v_dot2_f32_bf16 v40, v124, s41, v159
    v_dot2_f32_bf16 v41, v124, s42, v159
    v_dot2_f32_bf16 v42, v125, s41, v159
    v_dot2_f32_bf16 v43, v125, s42, v159
    v_dot2_f32_bf16 v44, v126, s41, v159
    v_dot2_f32_bf16 v45, v126, s42, v159
    v_dot2_f32_bf16 v46, v127, s41, v159
    v_dot2_f32_bf16 v47, v127, s42, v159
    v_cvt_pk_bf16_f32 v16, 0, v16
    v_cvt_pk_bf16_f32 v17, 0, v17
    v_cvt_pk_bf16_f32 v18, 0, v18
    v_cvt_pk_bf16_f32 v19, 0, v19
    v_cvt_pk_bf16_f32 v20, 0, v20
    v_cvt_pk_bf16_f32 v21, 0, v21
    v_cvt_pk_bf16_f32 v22, 0, v22
    v_cvt_pk_bf16_f32 v23, 0, v23
    v_cvt_pk_bf16_f32 v24, 0, v24
    v_cvt_pk_bf16_f32 v25, 0, v25
    v_cvt_pk_bf16_f32 v26, 0, v26
    v_cvt_pk_bf16_f32 v27, 0, v27
    v_cvt_pk_bf16_f32 v28, 0, v28
    v_cvt_pk_bf16_f32 v29, 0, v29
    v_cvt_pk_bf16_f32 v30, 0, v30
    v_cvt_pk_bf16_f32 v31, 0, v31
    v_cvt_pk_bf16_f32 v32, 0, v32
    v_cvt_pk_bf16_f32 v33, 0, v33
    v_cvt_pk_bf16_f32 v34, 0, v34
    v_cvt_pk_bf16_f32 v35, 0, v35
    v_cvt_pk_bf16_f32 v36, 0, v36
    v_cvt_pk_bf16_f32 v37, 0, v37
    v_cvt_pk_bf16_f32 v38, 0, v38
    v_cvt_pk_bf16_f32 v39, 0, v39
    v_cvt_pk_bf16_f32 v40, 0, v40
    v_cvt_pk_bf16_f32 v41, 0, v41
    v_cvt_pk_bf16_f32 v42, 0, v42
    v_cvt_pk_bf16_f32 v43, 0, v43
    v_cvt_pk_bf16_f32 v44, 0, v44
    v_cvt_pk_bf16_f32 v45, 0, v45
    v_cvt_pk_bf16_f32 v46, 0, v46
    v_cvt_pk_bf16_f32 v47, 0, v47
    v_mul_f32 v16, v16, v158
    v_mul_f32 v17, v17, v158
    v_mul_f32 v18, v18, v158
    v_mul_f32 v19, v19, v158
    v_mul_f32 v20, v20, v158
    v_mul_f32 v21, v21, v158
    v_mul_f32 v22, v22, v158
    v_mul_f32 v23, v23, v158
    v_mul_f32 v24, v24, v158
    v_mul_f32 v25, v25, v158
    v_mul_f32 v26, v26, v158
    v_mul_f32 v27, v27, v158
    v_mul_f32 v28, v28, v158
    v_mul_f32 v29, v29, v158
    v_mul_f32 v30, v30, v158
    v_mul_f32 v31, v31, v158
    v_mul_f32 v32, v32, v158
    v_mul_f32 v33, v33, v158
    v_mul_f32 v34, v34, v158
    v_mul_f32 v35, v35, v158
    v_mul_f32 v36, v36, v158
    v_mul_f32 v37, v37, v158
    v_mul_f32 v38, v38, v158
    v_mul_f32 v39, v39, v158
    v_mul_f32 v40, v40, v158
    v_mul_f32 v41, v41, v158
    v_mul_f32 v42, v42, v158
    v_mul_f32 v43, v43, v158
    v_mul_f32 v44, v44, v158
    v_mul_f32 v45, v45, v158
    v_mul_f32 v46, v46, v158
    v_mul_f32 v47, v47, v158
    v_cvt_pk_bf16_f32 v112, v16, v17
    v_cvt_pk_bf16_f32 v113, v18, v19
    v_cvt_pk_bf16_f32 v114, v20, v21
    v_cvt_pk_bf16_f32 v115, v22, v23
    v_cvt_pk_bf16_f32 v116, v24, v25
    v_cvt_pk_bf16_f32 v117, v26, v27
    v_cvt_pk_bf16_f32 v118, v28, v29
    v_cvt_pk_bf16_f32 v119, v30, v31
    v_cvt_pk_bf16_f32 v120, v32, v33
    v_cvt_pk_bf16_f32 v121, v34, v35
    v_cvt_pk_bf16_f32 v122, v36, v37
    v_cvt_pk_bf16_f32 v123, v38, v39
    v_cvt_pk_bf16_f32 v124, v40, v41
    v_cvt_pk_bf16_f32 v125, v42, v43
    v_cvt_pk_bf16_f32 v126, v44, v45
    v_cvt_pk_bf16_f32 v127, v46, v47
    ds_write_b128 v6, v[112:115] offset:12480
    ds_write_b128 v6, v[116:119] offset:12736
    ds_write_b128 v6, v[120:123] offset:12992
    ds_write_b128 v6, v[124:127] offset:13248
    v_dot2_f32_bf16 v152, v112, v48, 0
    v_dot2_f32_bf16 v153, v113, v49, 0
    v_dot2_f32_bf16 v152, v114, v50, v152
    v_dot2_f32_bf16 v153, v115, v51, v153
    v_dot2_f32_bf16 v152, v116, v52, v152
    v_dot2_f32_bf16 v153, v117, v53, v153
    v_dot2_f32_bf16 v152, v118, v54, v152
    v_dot2_f32_bf16 v153, v119, v55, v153
    v_dot2_f32_bf16 v152, v120, v56, v152
    v_dot2_f32_bf16 v153, v121, v57, v153
    v_dot2_f32_bf16 v152, v122, v58, v152
    v_dot2_f32_bf16 v153, v123, v59, v153
    v_dot2_f32_bf16 v152, v124, v60, v152
    v_dot2_f32_bf16 v153, v125, v61, v153
    v_dot2_f32_bf16 v152, v126, v62, v152
    v_dot2_f32_bf16 v153, v127, v63, v153
    s_nop 2
    v_add_f32 v152, v152, v153
    s_nop 1
    v_add_f32_dpp v152, v152, v152 row_ror:8 row_mask:0xf bank_mask:0xf
    s_nop 1
    v_add_f32_dpp v152, v152, v152 row_ror:4 row_mask:0xf bank_mask:0xf
    s_nop 1
    v_add_f32_dpp v152, v152, v152 row_ror:2 row_mask:0xf bank_mask:0xf
    s_nop 1
    v_add_f32_dpp v152, v152, v152 row_ror:1 row_mask:0xf bank_mask:0xf
    v_cvt_pk_bf16_f32 v152, 0, v152
    v_ashrrev_i32 v153, 31, v152
    v_or_b32 v153, 0x80000000, v153
    v_xor_b32 v152, v152, v153
    v_and_b32 v152, 0xffff0000, v152
    v_lshrrev_b32 v153, 2, v8
    v_sub_u32 v153, 2035, v153
    v_or_b32 v152, v152, v153

    s_cmp_lg_u32 s29, 0
    s_cbranch_scc1 k1_skipkey_7
    v_cmp_eq_u32 vcc, 0, v4
    s_and_saveexec_b64 s[44:45], vcc
    s_mov_b32 s36, 10485808
    buffer_store_dword v152, v8, s[24:27], s36 offen
    s_mov_b64 exec, s[44:45]

k1_skipkey_7:
    s_lshl_b32 s36, s30, 1
    s_add_u32 s36, s36, 1
    s_cmp_lg_u32 s29, s36
    s_cbranch_scc1 k1_skipxn_8

    buffer_store_dwordx4 v[112:115], v5, s[24:27], s35 offen offset:0
    buffer_store_dwordx4 v[116:119], v5, s[24:27], s35 offen offset:256
    buffer_store_dwordx4 v[120:123], v5, s[24:27], s35 offen offset:512
    buffer_store_dwordx4 v[124:127], v5, s[24:27], s35 offen offset:768
k1_skipxn_8:
    s_cmp_lg_u32 s2, 0
    s_cbranch_scc1 k1_skipy
    v_mov_b32 v16, 0
    v_mov_b32 v17, 0
    v_mov_b32 v18, 0
    v_mov_b32 v19, 0
    v_lshlrev_b32 v20, 6, v0
    s_mov_b32 s36, 10551296
    buffer_store_dwordx4 v[16:19], v20, s[24:27], s36 offen
    buffer_store_dwordx4 v[16:19], v20, s[24:27], s36 offen offset:16
    buffer_store_dwordx4 v[16:19], v20, s[24:27], s36 offen offset:32
    buffer_store_dwordx4 v[16:19], v20, s[24:27], s36 offen offset:48

k1_skipy:
    v_mov_b32 v160, 0
    v_mov_b32 v161, 0
    v_mov_b32 v162, 0
    v_mov_b32 v163, 0
    v_mov_b32 v164, 0
    v_mov_b32 v165, 0
    v_mov_b32 v166, 0
    v_mov_b32 v167, 0
    v_mov_b32 v168, 0
    v_mov_b32 v169, 0
    v_mov_b32 v170, 0
    v_mov_b32 v171, 0
    v_mov_b32 v172, 0
    v_mov_b32 v173, 0
    v_mov_b32 v174, 0
    v_mov_b32 v175, 0
    v_mov_b32 v176, 0
    v_mov_b32 v177, 0
    v_mov_b32 v178, 0
    v_mov_b32 v179, 0
    v_mov_b32 v180, 0
    v_mov_b32 v181, 0
    v_mov_b32 v182, 0
    v_mov_b32 v183, 0
    v_mov_b32 v184, 0
    v_mov_b32 v185, 0
    v_mov_b32 v186, 0
    v_mov_b32 v187, 0
    v_mov_b32 v188, 0
    v_mov_b32 v189, 0
    v_mov_b32 v190, 0
    v_mov_b32 v191, 0
    v_mov_b32 v192, 0
    v_mov_b32 v193, 0
    v_mov_b32 v194, 0
    v_mov_b32 v195, 0
    v_mov_b32 v196, 0
    v_mov_b32 v197, 0
    v_mov_b32 v198, 0
    v_mov_b32 v199, 0
    v_mov_b32 v200, 0
    v_mov_b32 v201, 0
    v_mov_b32 v202, 0
    v_mov_b32 v203, 0
    v_mov_b32 v204, 0
    v_mov_b32 v205, 0
    v_mov_b32 v206, 0
    v_mov_b32 v207, 0
    s_waitcnt lgkmcnt(0)
    s_waitcnt vmcnt(14)
    s_barrier
    ds_read_b128 v[208:211], v13 offset:0
    ds_read_b64_tr_b16 v[216:217], v14 offset:0
    ds_read_b64_tr_b16 v[218:219], v14 offset:1792
    ds_read_b64_tr_b16 v[220:221], v14 offset:128
    ds_read_b64_tr_b16 v[222:223], v14 offset:1920
    ds_read_b64_tr_b16 v[224:225], v14 offset:256
    ds_read_b64_tr_b16 v[226:227], v14 offset:2048
    ds_read_b128 v[212:215], v13 offset:32
    ds_read_b64_tr_b16 v[228:229], v14 offset:7168
    ds_read_b64_tr_b16 v[230:231], v14 offset:8960
    ds_read_b64_tr_b16 v[232:233], v14 offset:7296
    ds_read_b64_tr_b16 v[234:235], v14 offset:9088
    ds_read_b64_tr_b16 v[236:237], v14 offset:7424
    ds_read_b64_tr_b16 v[238:239], v14 offset:9216
    s_waitcnt lgkmcnt(7)
    v_mfma_f32_32x32x16_bf16 v[160:175], v[216:219], v[208:211], v[160:175]
    v_mfma_f32_32x32x16_bf16 v[176:191], v[220:223], v[208:211], v[176:191]
    v_mfma_f32_32x32x16_bf16 v[192:207], v[208:211], v[224:227], v[192:207]
    ds_read_b128 v[208:211], v13 offset:64
    ds_read_b64_tr_b16 v[216:217], v14 offset:14336
    ds_read_b64_tr_b16 v[218:219], v14 offset:16128
    ds_read_b64_tr_b16 v[220:221], v14 offset:14464
    ds_read_b64_tr_b16 v[222:223], v14 offset:16256
    ds_read_b64_tr_b16 v[224:225], v14 offset:14592
    ds_read_b64_tr_b16 v[226:227], v14 offset:16384
    s_waitcnt lgkmcnt(7)
    v_mfma_f32_32x32x16_bf16 v[160:175], v[228:231], v[212:215], v[160:175]
    v_mfma_f32_32x32x16_bf16 v[176:191], v[232:235], v[212:215], v[176:191]
    v_mfma_f32_32x32x16_bf16 v[192:207], v[212:215], v[236:239], v[192:207]
    ds_read_b128 v[212:215], v13 offset:96
    ds_read_b64_tr_b16 v[228:229], v14 offset:21504
    ds_read_b64_tr_b16 v[230:231], v14 offset:23296
    ds_read_b64_tr_b16 v[232:233], v14 offset:21632
    ds_read_b64_tr_b16 v[234:235], v14 offset:23424
    ds_read_b64_tr_b16 v[236:237], v14 offset:21760
    ds_read_b64_tr_b16 v[238:239], v14 offset:23552
    s_waitcnt lgkmcnt(7)
    v_mfma_f32_32x32x16_bf16 v[160:175], v[216:219], v[208:211], v[160:175]
    v_mfma_f32_32x32x16_bf16 v[176:191], v[220:223], v[208:211], v[176:191]
    v_mfma_f32_32x32x16_bf16 v[192:207], v[208:211], v[224:227], v[192:207]
    s_waitcnt lgkmcnt(0)
    v_mfma_f32_32x32x16_bf16 v[160:175], v[228:231], v[212:215], v[160:175]
    v_mfma_f32_32x32x16_bf16 v[176:191], v[232:235], v[212:215], v[176:191]
    v_mfma_f32_32x32x16_bf16 v[192:207], v[212:215], v[236:239], v[192:207]
    s_waitcnt vmcnt(7)
    s_barrier
    s_mov_b32 s39, 589824
    s_add_u32 s38, s37, 66560
    s_mov_b32 m0, s38
    s_nop 0
    buffer_load_dwordx4 v128, s[16:19], s39 offen lds
    s_add_u32 s38, s37, 67584
    s_mov_b32 m0, s38
    s_nop 0
    buffer_load_dwordx4 v129, s[16:19], s39 offen lds
    s_add_u32 s38, s37, 68608
    s_mov_b32 m0, s38
    s_nop 0
    buffer_load_dwordx4 v130, s[16:19], s39 offen lds
    s_add_u32 s38, s37, 69632
    s_mov_b32 m0, s38
    s_nop 0
    buffer_load_dwordx4 v131, s[16:19], s39 offen lds
    s_add_u32 s38, s37, 70656
    s_mov_b32 m0, s38
    s_nop 0
    buffer_load_dwordx4 v132, s[16:19], s39 offen lds
    s_add_u32 s38, s37, 71680
    s_mov_b32 m0, s38
    s_nop 0
    buffer_load_dwordx4 v133, s[16:19], s39 offen lds
    s_add_u32 s38, s37, 72704
    s_mov_b32 m0, s38
    s_nop 0
    buffer_load_dwordx4 v134, s[16:19], s39 offen lds
    ds_read_b128 v[208:211], v13 offset:128
    ds_read_b64_tr_b16 v[216:217], v15 offset:0
    ds_read_b64_tr_b16 v[218:219], v15 offset:1792
    ds_read_b64_tr_b16 v[220:221], v15 offset:128
    ds_read_b64_tr_b16 v[222:223], v15 offset:1920
    ds_read_b64_tr_b16 v[224:225], v15 offset:256
    ds_read_b64_tr_b16 v[226:227], v15 offset:2048
    ds_read_b128 v[212:215], v13 offset:160
    ds_read_b64_tr_b16 v[228:229], v15 offset:7168
    ds_read_b64_tr_b16 v[230:231], v15 offset:8960
    ds_read_b64_tr_b16 v[232:233], v15 offset:7296
    ds_read_b64_tr_b16 v[234:235], v15 offset:9088
    ds_read_b64_tr_b16 v[236:237], v15 offset:7424
    ds_read_b64_tr_b16 v[238:239], v15 offset:9216
    s_waitcnt lgkmcnt(7)
    v_mfma_f32_32x32x16_bf16 v[160:175], v[216:219], v[208:211], v[160:175]
    v_mfma_f32_32x32x16_bf16 v[176:191], v[220:223], v[208:211], v[176:191]
    v_mfma_f32_32x32x16_bf16 v[192:207], v[208:211], v[224:227], v[192:207]
    ds_read_b128 v[208:211], v13 offset:192
    ds_read_b64_tr_b16 v[216:217], v15 offset:14336
    ds_read_b64_tr_b16 v[218:219], v15 offset:16128
    ds_read_b64_tr_b16 v[220:221], v15 offset:14464
    ds_read_b64_tr_b16 v[222:223], v15 offset:16256
    ds_read_b64_tr_b16 v[224:225], v15 offset:14592
    ds_read_b64_tr_b16 v[226:227], v15 offset:16384
    s_waitcnt lgkmcnt(7)
    v_mfma_f32_32x32x16_bf16 v[160:175], v[228:231], v[212:215], v[160:175]
    v_mfma_f32_32x32x16_bf16 v[176:191], v[232:235], v[212:215], v[176:191]
    v_mfma_f32_32x32x16_bf16 v[192:207], v[212:215], v[236:239], v[192:207]
    ds_read_b128 v[212:215], v13 offset:224
    ds_read_b64_tr_b16 v[228:229], v15 offset:21504
    ds_read_b64_tr_b16 v[230:231], v15 offset:23296
    ds_read_b64_tr_b16 v[232:233], v15 offset:21632
    ds_read_b64_tr_b16 v[234:235], v15 offset:23424
    ds_read_b64_tr_b16 v[236:237], v15 offset:21760
    ds_read_b64_tr_b16 v[238:239], v15 offset:23552
    s_waitcnt lgkmcnt(7)
    v_mfma_f32_32x32x16_bf16 v[160:175], v[216:219], v[208:211], v[160:175]
    v_mfma_f32_32x32x16_bf16 v[176:191], v[220:223], v[208:211], v[176:191]
    v_mfma_f32_32x32x16_bf16 v[192:207], v[208:211], v[224:227], v[192:207]
    s_waitcnt lgkmcnt(0)
    v_mfma_f32_32x32x16_bf16 v[160:175], v[228:231], v[212:215], v[160:175]
    v_mfma_f32_32x32x16_bf16 v[176:191], v[232:235], v[212:215], v[176:191]
    v_mfma_f32_32x32x16_bf16 v[192:207], v[212:215], v[236:239], v[192:207]
    s_waitcnt vmcnt(7)
    s_barrier
    s_mov_b32 s39, 786432
    s_add_u32 s38, s37, 95232
    s_mov_b32 m0, s38
    s_nop 0
    buffer_load_dwordx4 v128, s[16:19], s39 offen lds
    s_add_u32 s38, s37, 96256
    s_mov_b32 m0, s38
    s_nop 0
    buffer_load_dwordx4 v129, s[16:19], s39 offen lds
    s_add_u32 s38, s37, 97280
    s_mov_b32 m0, s38
    s_nop 0
    buffer_load_dwordx4 v130, s[16:19], s39 offen lds
    s_add_u32 s38, s37, 98304
    s_mov_b32 m0, s38
    s_nop 0
    buffer_load_dwordx4 v131, s[16:19], s39 offen lds
    s_add_u32 s38, s37, 99328
    s_mov_b32 m0, s38
    s_nop 0
    buffer_load_dwordx4 v132, s[16:19], s39 offen lds
    s_add_u32 s38, s37, 100352
    s_mov_b32 m0, s38
    s_nop 0
    buffer_load_dwordx4 v133, s[16:19], s39 offen lds
    s_add_u32 s38, s37, 101376
    s_mov_b32 m0, s38
    s_nop 0
    buffer_load_dwordx4 v134, s[16:19], s39 offen lds
    ds_read_b128 v[208:211], v13 offset:256
    ds_read_b64_tr_b16 v[216:217], v135 offset:0
    ds_read_b64_tr_b16 v[218:219], v135 offset:1792
    ds_read_b64_tr_b16 v[220:221], v135 offset:128
    ds_read_b64_tr_b16 v[222:223], v135 offset:1920
    ds_read_b64_tr_b16 v[224:225], v135 offset:256
    ds_read_b64_tr_b16 v[226:227], v135 offset:2048
    ds_read_b128 v[212:215], v13 offset:288
    ds_read_b64_tr_b16 v[228:229], v135 offset:7168
    ds_read_b64_tr_b16 v[230:231], v135 offset:8960
    ds_read_b64_tr_b16 v[232:233], v135 offset:7296
    ds_read_b64_tr_b16 v[234:235], v135 offset:9088
    ds_read_b64_tr_b16 v[236:237], v135 offset:7424
    ds_read_b64_tr_b16 v[238:239], v135 offset:9216
    s_waitcnt lgkmcnt(7)
    v_mfma_f32_32x32x16_bf16 v[160:175], v[216:219], v[208:211], v[160:175]
    v_mfma_f32_32x32x16_bf16 v[176:191], v[220:223], v[208:211], v[176:191]
    v_mfma_f32_32x32x16_bf16 v[192:207], v[208:211], v[224:227], v[192:207]
    ds_read_b128 v[208:211], v13 offset:320
    ds_read_b64_tr_b16 v[216:217], v135 offset:14336
    ds_read_b64_tr_b16 v[218:219], v135 offset:16128
    ds_read_b64_tr_b16 v[220:221], v135 offset:14464
    ds_read_b64_tr_b16 v[222:223], v135 offset:16256
    ds_read_b64_tr_b16 v[224:225], v135 offset:14592
    ds_read_b64_tr_b16 v[226:227], v135 offset:16384
    s_waitcnt lgkmcnt(7)
    v_mfma_f32_32x32x16_bf16 v[160:175], v[228:231], v[212:215], v[160:175]
    v_mfma_f32_32x32x16_bf16 v[176:191], v[232:235], v[212:215], v[176:191]
    v_mfma_f32_32x32x16_bf16 v[192:207], v[212:215], v[236:239], v[192:207]
    ds_read_b128 v[212:215], v13 offset:352
    ds_read_b64_tr_b16 v[228:229], v135 offset:21504
    ds_read_b64_tr_b16 v[230:231], v135 offset:23296
    ds_read_b64_tr_b16 v[232:233], v135 offset:21632
    ds_read_b64_tr_b16 v[234:235], v135 offset:23424
    ds_read_b64_tr_b16 v[236:237], v135 offset:21760
    ds_read_b64_tr_b16 v[238:239], v135 offset:23552
    s_waitcnt lgkmcnt(7)
    v_mfma_f32_32x32x16_bf16 v[160:175], v[216:219], v[208:211], v[160:175]
    v_mfma_f32_32x32x16_bf16 v[176:191], v[220:223], v[208:211], v[176:191]
    v_mfma_f32_32x32x16_bf16 v[192:207], v[208:211], v[224:227], v[192:207]
    s_waitcnt lgkmcnt(0)
    v_mfma_f32_32x32x16_bf16 v[160:175], v[228:231], v[212:215], v[160:175]
    v_mfma_f32_32x32x16_bf16 v[176:191], v[232:235], v[212:215], v[176:191]
    v_mfma_f32_32x32x16_bf16 v[192:207], v[212:215], v[236:239], v[192:207]
    s_waitcnt vmcnt(7)
    s_barrier
    s_mov_b32 s39, 983040
    s_add_u32 s38, s37, 123904
    s_mov_b32 m0, s38
    s_nop 0
    buffer_load_dwordx4 v128, s[16:19], s39 offen lds
    s_add_u32 s38, s37, 124928
    s_mov_b32 m0, s38
    s_nop 0
    buffer_load_dwordx4 v129, s[16:19], s39 offen lds
    s_add_u32 s38, s37, 125952
    s_mov_b32 m0, s38
    s_nop 0
    buffer_load_dwordx4 v130, s[16:19], s39 offen lds
    s_add_u32 s38, s37, 126976
    s_mov_b32 m0, s38
    s_nop 0
    buffer_load_dwordx4 v131, s[16:19], s39 offen lds
    s_add_u32 s38, s37, 128000
    s_mov_b32 m0, s38
    s_nop 0
    buffer_load_dwordx4 v132, s[16:19], s39 offen lds
    s_add_u32 s38, s37, 129024
    s_mov_b32 m0, s38
    s_nop 0
    buffer_load_dwordx4 v133, s[16:19], s39 offen lds
    s_add_u32 s38, s37, 130048
    s_mov_b32 m0, s38
    s_nop 0
    buffer_load_dwordx4 v134, s[16:19], s39 offen lds
    ds_read_b128 v[208:211], v13 offset:384
    ds_read_b64_tr_b16 v[216:217], v14 offset:0
    ds_read_b64_tr_b16 v[218:219], v14 offset:1792
    ds_read_b64_tr_b16 v[220:221], v14 offset:128
    ds_read_b64_tr_b16 v[222:223], v14 offset:1920
    ds_read_b64_tr_b16 v[224:225], v14 offset:256
    ds_read_b64_tr_b16 v[226:227], v14 offset:2048
    ds_read_b128 v[212:215], v13 offset:416
    ds_read_b64_tr_b16 v[228:229], v14 offset:7168
    ds_read_b64_tr_b16 v[230:231], v14 offset:8960
    ds_read_b64_tr_b16 v[232:233], v14 offset:7296
    ds_read_b64_tr_b16 v[234:235], v14 offset:9088
    ds_read_b64_tr_b16 v[236:237], v14 offset:7424
    ds_read_b64_tr_b16 v[238:239], v14 offset:9216
    s_waitcnt lgkmcnt(7)
    v_mfma_f32_32x32x16_bf16 v[160:175], v[216:219], v[208:211], v[160:175]
    v_mfma_f32_32x32x16_bf16 v[176:191], v[220:223], v[208:211], v[176:191]
    v_mfma_f32_32x32x16_bf16 v[192:207], v[208:211], v[224:227], v[192:207]
    ds_read_b128 v[208:211], v13 offset:448
    ds_read_b64_tr_b16 v[216:217], v14 offset:14336
    ds_read_b64_tr_b16 v[218:219], v14 offset:16128
    ds_read_b64_tr_b16 v[220:221], v14 offset:14464
    ds_read_b64_tr_b16 v[222:223], v14 offset:16256
    ds_read_b64_tr_b16 v[224:225], v14 offset:14592
    ds_read_b64_tr_b16 v[226:227], v14 offset:16384
    s_waitcnt lgkmcnt(7)
    v_mfma_f32_32x32x16_bf16 v[160:175], v[228:231], v[212:215], v[160:175]
    v_mfma_f32_32x32x16_bf16 v[176:191], v[232:235], v[212:215], v[176:191]
    v_mfma_f32_32x32x16_bf16 v[192:207], v[212:215], v[236:239], v[192:207]
    ds_read_b128 v[212:215], v13 offset:480
    ds_read_b64_tr_b16 v[228:229], v14 offset:21504
    ds_read_b64_tr_b16 v[230:231], v14 offset:23296
    ds_read_b64_tr_b16 v[232:233], v14 offset:21632
    ds_read_b64_tr_b16 v[234:235], v14 offset:23424
    ds_read_b64_tr_b16 v[236:237], v14 offset:21760
    ds_read_b64_tr_b16 v[238:239], v14 offset:23552
    s_waitcnt lgkmcnt(7)
    v_mfma_f32_32x32x16_bf16 v[160:175], v[216:219], v[208:211], v[160:175]
    v_mfma_f32_32x32x16_bf16 v[176:191], v[220:223], v[208:211], v[176:191]
    v_mfma_f32_32x32x16_bf16 v[192:207], v[208:211], v[224:227], v[192:207]
    s_waitcnt lgkmcnt(0)
    v_mfma_f32_32x32x16_bf16 v[160:175], v[228:231], v[212:215], v[160:175]
    v_mfma_f32_32x32x16_bf16 v[176:191], v[232:235], v[212:215], v[176:191]
    v_mfma_f32_32x32x16_bf16 v[192:207], v[212:215], v[236:239], v[192:207]
    s_waitcnt vmcnt(7)
    s_barrier
    s_mov_b32 s39, 1179648
    s_add_u32 s38, s37, 66560
    s_mov_b32 m0, s38
    s_nop 0
    buffer_load_dwordx4 v128, s[16:19], s39 offen lds
    s_add_u32 s38, s37, 67584
    s_mov_b32 m0, s38
    s_nop 0
    buffer_load_dwordx4 v129, s[16:19], s39 offen lds
    s_add_u32 s38, s37, 68608
    s_mov_b32 m0, s38
    s_nop 0
    buffer_load_dwordx4 v130, s[16:19], s39 offen lds
    s_add_u32 s38, s37, 69632
    s_mov_b32 m0, s38
    s_nop 0
    buffer_load_dwordx4 v131, s[16:19], s39 offen lds
    s_add_u32 s38, s37, 70656
    s_mov_b32 m0, s38
    s_nop 0
    buffer_load_dwordx4 v132, s[16:19], s39 offen lds
    s_add_u32 s38, s37, 71680
    s_mov_b32 m0, s38
    s_nop 0
    buffer_load_dwordx4 v133, s[16:19], s39 offen lds
    s_add_u32 s38, s37, 72704
    s_mov_b32 m0, s38
    s_nop 0
    buffer_load_dwordx4 v134, s[16:19], s39 offen lds
    ds_read_b128 v[208:211], v13 offset:512
    ds_read_b64_tr_b16 v[216:217], v15 offset:0
    ds_read_b64_tr_b16 v[218:219], v15 offset:1792
    ds_read_b64_tr_b16 v[220:221], v15 offset:128
    ds_read_b64_tr_b16 v[222:223], v15 offset:1920
    ds_read_b64_tr_b16 v[224:225], v15 offset:256
    ds_read_b64_tr_b16 v[226:227], v15 offset:2048
    ds_read_b128 v[212:215], v13 offset:544
    ds_read_b64_tr_b16 v[228:229], v15 offset:7168
    ds_read_b64_tr_b16 v[230:231], v15 offset:8960
    ds_read_b64_tr_b16 v[232:233], v15 offset:7296
    ds_read_b64_tr_b16 v[234:235], v15 offset:9088
    ds_read_b64_tr_b16 v[236:237], v15 offset:7424
    ds_read_b64_tr_b16 v[238:239], v15 offset:9216
    s_waitcnt lgkmcnt(7)
    v_mfma_f32_32x32x16_bf16 v[160:175], v[216:219], v[208:211], v[160:175]
    v_mfma_f32_32x32x16_bf16 v[176:191], v[220:223], v[208:211], v[176:191]
    v_mfma_f32_32x32x16_bf16 v[192:207], v[208:211], v[224:227], v[192:207]
    ds_read_b128 v[208:211], v13 offset:576
    ds_read_b64_tr_b16 v[216:217], v15 offset:14336
    ds_read_b64_tr_b16 v[218:219], v15 offset:16128
    ds_read_b64_tr_b16 v[220:221], v15 offset:14464
    ds_read_b64_tr_b16 v[222:223], v15 offset:16256
    ds_read_b64_tr_b16 v[224:225], v15 offset:14592
    ds_read_b64_tr_b16 v[226:227], v15 offset:16384
    s_waitcnt lgkmcnt(7)
    v_mfma_f32_32x32x16_bf16 v[160:175], v[228:231], v[212:215], v[160:175]
    v_mfma_f32_32x32x16_bf16 v[176:191], v[232:235], v[212:215], v[176:191]
    v_mfma_f32_32x32x16_bf16 v[192:207], v[212:215], v[236:239], v[192:207]
    ds_read_b128 v[212:215], v13 offset:608
    ds_read_b64_tr_b16 v[228:229], v15 offset:21504
    ds_read_b64_tr_b16 v[230:231], v15 offset:23296
    ds_read_b64_tr_b16 v[232:233], v15 offset:21632
    ds_read_b64_tr_b16 v[234:235], v15 offset:23424
    ds_read_b64_tr_b16 v[236:237], v15 offset:21760
    ds_read_b64_tr_b16 v[238:239], v15 offset:23552
    s_waitcnt lgkmcnt(7)
    v_mfma_f32_32x32x16_bf16 v[160:175], v[216:219], v[208:211], v[160:175]
    v_mfma_f32_32x32x16_bf16 v[176:191], v[220:223], v[208:211], v[176:191]
    v_mfma_f32_32x32x16_bf16 v[192:207], v[208:211], v[224:227], v[192:207]
    s_waitcnt lgkmcnt(0)
    v_mfma_f32_32x32x16_bf16 v[160:175], v[228:231], v[212:215], v[160:175]
    v_mfma_f32_32x32x16_bf16 v[176:191], v[232:235], v[212:215], v[176:191]
    v_mfma_f32_32x32x16_bf16 v[192:207], v[212:215], v[236:239], v[192:207]
    s_waitcnt vmcnt(7)
    s_barrier
    s_mov_b32 s39, 1376256
    s_add_u32 s38, s37, 95232
    s_mov_b32 m0, s38
    s_nop 0
    buffer_load_dwordx4 v128, s[16:19], s39 offen lds
    s_add_u32 s38, s37, 96256
    s_mov_b32 m0, s38
    s_nop 0
    buffer_load_dwordx4 v129, s[16:19], s39 offen lds
    s_add_u32 s38, s37, 97280
    s_mov_b32 m0, s38
    s_nop 0
    buffer_load_dwordx4 v130, s[16:19], s39 offen lds
    s_add_u32 s38, s37, 98304
    s_mov_b32 m0, s38
    s_nop 0
    buffer_load_dwordx4 v131, s[16:19], s39 offen lds
    s_add_u32 s38, s37, 99328
    s_mov_b32 m0, s38
    s_nop 0
    buffer_load_dwordx4 v132, s[16:19], s39 offen lds
    s_add_u32 s38, s37, 100352
    s_mov_b32 m0, s38
    s_nop 0
    buffer_load_dwordx4 v133, s[16:19], s39 offen lds
    s_add_u32 s38, s37, 101376
    s_mov_b32 m0, s38
    s_nop 0
    buffer_load_dwordx4 v134, s[16:19], s39 offen lds
    ds_read_b128 v[208:211], v13 offset:640
    ds_read_b64_tr_b16 v[216:217], v135 offset:0
    ds_read_b64_tr_b16 v[218:219], v135 offset:1792
    ds_read_b64_tr_b16 v[220:221], v135 offset:128
    ds_read_b64_tr_b16 v[222:223], v135 offset:1920
    ds_read_b64_tr_b16 v[224:225], v135 offset:256
    ds_read_b64_tr_b16 v[226:227], v135 offset:2048
    ds_read_b128 v[212:215], v13 offset:672
    ds_read_b64_tr_b16 v[228:229], v135 offset:7168
    ds_read_b64_tr_b16 v[230:231], v135 offset:8960
    ds_read_b64_tr_b16 v[232:233], v135 offset:7296
    ds_read_b64_tr_b16 v[234:235], v135 offset:9088
    ds_read_b64_tr_b16 v[236:237], v135 offset:7424
    ds_read_b64_tr_b16 v[238:239], v135 offset:9216
    s_waitcnt lgkmcnt(7)
    v_mfma_f32_32x32x16_bf16 v[160:175], v[216:219], v[208:211], v[160:175]
    v_mfma_f32_32x32x16_bf16 v[176:191], v[220:223], v[208:211], v[176:191]
    v_mfma_f32_32x32x16_bf16 v[192:207], v[208:211], v[224:227], v[192:207]
    ds_read_b128 v[208:211], v13 offset:704
    ds_read_b64_tr_b16 v[216:217], v135 offset:14336
    ds_read_b64_tr_b16 v[218:219], v135 offset:16128
    ds_read_b64_tr_b16 v[220:221], v135 offset:14464
    ds_read_b64_tr_b16 v[222:223], v135 offset:16256
    ds_read_b64_tr_b16 v[224:225], v135 offset:14592
    ds_read_b64_tr_b16 v[226:227], v135 offset:16384
    s_waitcnt lgkmcnt(7)
    v_mfma_f32_32x32x16_bf16 v[160:175], v[228:231], v[212:215], v[160:175]
    v_mfma_f32_32x32x16_bf16 v[176:191], v[232:235], v[212:215], v[176:191]
    v_mfma_f32_32x32x16_bf16 v[192:207], v[212:215], v[236:239], v[192:207]
    ds_read_b128 v[212:215], v13 offset:736
    ds_read_b64_tr_b16 v[228:229], v135 offset:21504
    ds_read_b64_tr_b16 v[230:231], v135 offset:23296
    ds_read_b64_tr_b16 v[232:233], v135 offset:21632
    ds_read_b64_tr_b16 v[234:235], v135 offset:23424
    ds_read_b64_tr_b16 v[236:237], v135 offset:21760
    ds_read_b64_tr_b16 v[238:239], v135 offset:23552
    s_waitcnt lgkmcnt(7)
    v_mfma_f32_32x32x16_bf16 v[160:175], v[216:219], v[208:211], v[160:175]
    v_mfma_f32_32x32x16_bf16 v[176:191], v[220:223], v[208:211], v[176:191]
    v_mfma_f32_32x32x16_bf16 v[192:207], v[208:211], v[224:227], v[192:207]
    s_waitcnt lgkmcnt(0)
    v_mfma_f32_32x32x16_bf16 v[160:175], v[228:231], v[212:215], v[160:175]
    v_mfma_f32_32x32x16_bf16 v[176:191], v[232:235], v[212:215], v[176:191]
    v_mfma_f32_32x32x16_bf16 v[192:207], v[212:215], v[236:239], v[192:207]
    s_waitcnt vmcnt(7)
    s_barrier
    ds_read_b128 v[208:211], v13 offset:768
    ds_read_b64_tr_b16 v[216:217], v14 offset:0
    ds_read_b64_tr_b16 v[218:219], v14 offset:1792
    ds_read_b64_tr_b16 v[220:221], v14 offset:128
    ds_read_b64_tr_b16 v[222:223], v14 offset:1920
    ds_read_b64_tr_b16 v[224:225], v14 offset:256
    ds_read_b64_tr_b16 v[226:227], v14 offset:2048
    ds_read_b128 v[212:215], v13 offset:800
    ds_read_b64_tr_b16 v[228:229], v14 offset:7168
    ds_read_b64_tr_b16 v[230:231], v14 offset:8960
    ds_read_b64_tr_b16 v[232:233], v14 offset:7296
    ds_read_b64_tr_b16 v[234:235], v14 offset:9088
    ds_read_b64_tr_b16 v[236:237], v14 offset:7424
    ds_read_b64_tr_b16 v[238:239], v14 offset:9216
    s_waitcnt lgkmcnt(7)
    v_mfma_f32_32x32x16_bf16 v[160:175], v[216:219], v[208:211], v[160:175]
    v_mfma_f32_32x32x16_bf16 v[176:191], v[220:223], v[208:211], v[176:191]
    v_mfma_f32_32x32x16_bf16 v[192:207], v[208:211], v[224:227], v[192:207]
    ds_read_b128 v[208:211], v13 offset:832
    ds_read_b64_tr_b16 v[216:217], v14 offset:14336
    ds_read_b64_tr_b16 v[218:219], v14 offset:16128
    ds_read_b64_tr_b16 v[220:221], v14 offset:14464
    ds_read_b64_tr_b16 v[222:223], v14 offset:16256
    ds_read_b64_tr_b16 v[224:225], v14 offset:14592
    ds_read_b64_tr_b16 v[226:227], v14 offset:16384
    s_waitcnt lgkmcnt(7)
    v_mfma_f32_32x32x16_bf16 v[160:175], v[228:231], v[212:215], v[160:175]
    v_mfma_f32_32x32x16_bf16 v[176:191], v[232:235], v[212:215], v[176:191]
    v_mfma_f32_32x32x16_bf16 v[192:207], v[212:215], v[236:239], v[192:207]
    ds_read_b128 v[212:215], v13 offset:864
    ds_read_b64_tr_b16 v[228:229], v14 offset:21504
    ds_read_b64_tr_b16 v[230:231], v14 offset:23296
    ds_read_b64_tr_b16 v[232:233], v14 offset:21632
    ds_read_b64_tr_b16 v[234:235], v14 offset:23424
    ds_read_b64_tr_b16 v[236:237], v14 offset:21760
    ds_read_b64_tr_b16 v[238:239], v14 offset:23552
    s_waitcnt lgkmcnt(7)
    v_mfma_f32_32x32x16_bf16 v[160:175], v[216:219], v[208:211], v[160:175]
    v_mfma_f32_32x32x16_bf16 v[176:191], v[220:223], v[208:211], v[176:191]
    v_mfma_f32_32x32x16_bf16 v[192:207], v[208:211], v[224:227], v[192:207]
    s_waitcnt lgkmcnt(0)
    v_mfma_f32_32x32x16_bf16 v[160:175], v[228:231], v[212:215], v[160:175]
    v_mfma_f32_32x32x16_bf16 v[176:191], v[232:235], v[212:215], v[176:191]
    v_mfma_f32_32x32x16_bf16 v[192:207], v[212:215], v[236:239], v[192:207]
    s_waitcnt vmcnt(0)
    s_barrier
    ds_read_b128 v[208:211], v13 offset:896
    ds_read_b64_tr_b16 v[216:217], v15 offset:0
    ds_read_b64_tr_b16 v[218:219], v15 offset:1792
    ds_read_b64_tr_b16 v[220:221], v15 offset:128
    ds_read_b64_tr_b16 v[222:223], v15 offset:1920
    ds_read_b64_tr_b16 v[224:225], v15 offset:256
    ds_read_b64_tr_b16 v[226:227], v15 offset:2048
    ds_read_b128 v[212:215], v13 offset:928
    ds_read_b64_tr_b16 v[228:229], v15 offset:7168
    ds_read_b64_tr_b16 v[230:231], v15 offset:8960
    ds_read_b64_tr_b16 v[232:233], v15 offset:7296
    ds_read_b64_tr_b16 v[234:235], v15 offset:9088
    ds_read_b64_tr_b16 v[236:237], v15 offset:7424
    ds_read_b64_tr_b16 v[238:239], v15 offset:9216
    s_waitcnt lgkmcnt(7)
    v_mfma_f32_32x32x16_bf16 v[160:175], v[216:219], v[208:211], v[160:175]
    v_mfma_f32_32x32x16_bf16 v[176:191], v[220:223], v[208:211], v[176:191]
    v_mfma_f32_32x32x16_bf16 v[192:207], v[208:211], v[224:227], v[192:207]
    ds_read_b128 v[208:211], v13 offset:960
    ds_read_b64_tr_b16 v[216:217], v15 offset:14336
    ds_read_b64_tr_b16 v[218:219], v15 offset:16128
    ds_read_b64_tr_b16 v[220:221], v15 offset:14464
    ds_read_b64_tr_b16 v[222:223], v15 offset:16256
    ds_read_b64_tr_b16 v[224:225], v15 offset:14592
    ds_read_b64_tr_b16 v[226:227], v15 offset:16384
    s_waitcnt lgkmcnt(7)
    v_mfma_f32_32x32x16_bf16 v[160:175], v[228:231], v[212:215], v[160:175]
    v_mfma_f32_32x32x16_bf16 v[176:191], v[232:235], v[212:215], v[176:191]
    v_mfma_f32_32x32x16_bf16 v[192:207], v[212:215], v[236:239], v[192:207]
    ds_read_b128 v[212:215], v13 offset:992
    ds_read_b64_tr_b16 v[228:229], v15 offset:21504
    ds_read_b64_tr_b16 v[230:231], v15 offset:23296
    ds_read_b64_tr_b16 v[232:233], v15 offset:21632
    ds_read_b64_tr_b16 v[234:235], v15 offset:23424
    ds_read_b64_tr_b16 v[236:237], v15 offset:21760
    ds_read_b64_tr_b16 v[238:239], v15 offset:23552
    s_waitcnt lgkmcnt(7)
    v_mfma_f32_32x32x16_bf16 v[160:175], v[216:219], v[208:211], v[160:175]
    v_mfma_f32_32x32x16_bf16 v[176:191], v[220:223], v[208:211], v[176:191]
    v_mfma_f32_32x32x16_bf16 v[192:207], v[208:211], v[224:227], v[192:207]
    s_waitcnt lgkmcnt(0)
    v_mfma_f32_32x32x16_bf16 v[160:175], v[228:231], v[212:215], v[160:175]
    v_mfma_f32_32x32x16_bf16 v[176:191], v[232:235], v[212:215], v[176:191]
    v_mfma_f32_32x32x16_bf16 v[192:207], v[212:215], v[236:239], v[192:207]
    s_nop 15
    s_nop 3
    v_and_b32 v16, 31, v2
    s_lshl_b32 s36, s28, 6
    s_and_b32 s37, s30, 1
    s_lshl_b32 s37, s37, 5
    s_add_u32 s36, s36, s37
    v_add_u32 v16, s36, v16
    v_lshlrev_b32 v16, 5, v16
    v_lshrrev_b32 v17, 5, v2
    v_lshl_add_u32 v16, v17, 4, v16
    s_lshl_b32 s36, s29, 2
    s_lshr_b32 s37, s30, 1
    s_lshl_b32 s37, s37, 1
    s_add_u32 s36, s36, s37
    s_lshl_b32 s36, s36, 16
    s_mov_b32 s38, 0x3eb8aa3b

    v_mul_f32 v160, s38, v160
    v_mul_f32 v161, s38, v161
    v_mul_f32 v162, s38, v162
    v_mul_f32 v163, s38, v163
    v_mul_f32 v164, s38, v164
    v_mul_f32 v165, s38, v165
    v_mul_f32 v166, s38, v166
    v_mul_f32 v167, s38, v167
    v_mul_f32 v168, s38, v168
    v_mul_f32 v169, s38, v169
    v_mul_f32 v170, s38, v170
    v_mul_f32 v171, s38, v171
    v_mul_f32 v172, s38, v172
    v_mul_f32 v173, s38, v173
    v_mul_f32 v174, s38, v174
    v_mul_f32 v175, s38, v175
    v_cvt_pk_bf16_f32 v20, v160, v161
    v_cvt_pk_bf16_f32 v28, v176, v177
    v_cvt_pk_bf16_f32 v21, v162, v163
    v_cvt_pk_bf16_f32 v29, v178, v179
    v_cvt_pk_bf16_f32 v22, v164, v165
    v_cvt_pk_bf16_f32 v30, v180, v181
    v_cvt_pk_bf16_f32 v23, v166, v167
    v_cvt_pk_bf16_f32 v31, v182, v183
    v_cvt_pk_bf16_f32 v24, v168, v169
    v_cvt_pk_bf16_f32 v32, v184, v185
    v_cvt_pk_bf16_f32 v25, v170, v171
    v_cvt_pk_bf16_f32 v33, v186, v187
    v_cvt_pk_bf16_f32 v26, v172, v173
    v_cvt_pk_bf16_f32 v34, v188, v189
    v_cvt_pk_bf16_f32 v27, v174, v175
    v_cvt_pk_bf16_f32 v35, v190, v191
    s_add_u32 s37, s36, 2097152
    buffer_store_dwordx4 v[20:23], v16, s[24:27], s37 offen
    s_add_u32 s37, s36, 2162688
    buffer_store_dwordx4 v[24:27], v16, s[24:27], s37 offen
    s_add_u32 s37, s36, 4194304
    buffer_store_dwordx4 v[28:31], v16, s[24:27], s37 offen
    s_add_u32 s37, s36, 4259840
    buffer_store_dwordx4 v[32:35], v16, s[24:27], s37 offen
    v_bfe_u32 v16, v2, 4, 1
    v_lshlrev_b32 v16, 16, v16
    v_lshrrev_b32 v17, 5, v2
    v_lshl_add_u32 v16, v17, 8, v16
    v_and_b32 v17, 15, v2
    v_lshl_add_u32 v16, v17, 4, v16
    s_lshl_b32 s37, s28, 1
    s_and_b32 s38, s30, 1
    s_add_u32 s37, s37, s38
    s_lshl_b32 s37, s37, 10
    s_add_u32 s37, s37, s36
    s_add_u32 s37, s37, 6291456

    v_cvt_pk_bf16_f32 v36, v192, v193
    v_cvt_pk_bf16_f32 v37, v194, v195
    v_cvt_pk_bf16_f32 v38, v196, v197
    v_cvt_pk_bf16_f32 v39, v198, v199
    v_cvt_pk_bf16_f32 v40, v200, v201
    v_cvt_pk_bf16_f32 v41, v202, v203
    v_cvt_pk_bf16_f32 v42, v204, v205
    v_cvt_pk_bf16_f32 v43, v206, v207
    buffer_store_dwordx4 v[36:39], v16, s[24:27], s37 offen
    buffer_store_dwordx4 v[40:43], v16, s[24:27], s37 offen offset:512
    s_waitcnt vmcnt(0)
k1_end:
    s_endpgm
.globl k2_kernel
.p2align 8
.type k2_kernel,@function
k2_kernel:
    s_cmp_ge_u32 s2, 256
    s_cbranch_scc1 k2_end
    s_load_dwordx2 s[4:5], s[0:1], 80
    v_lshrrev_b32 v1, 6, v0
    v_and_b32 v0, 63, v0
    s_and_b32 s13, s2, 7
    s_lshl_b32 s13, s13, 2
    s_bfe_u32 s14, s2, 0x20003
    s_add_u32 s13, s13, s14
    s_lshr_b32 s14, s2, 5
    v_readfirstlane_b32 s12, v1
    s_waitcnt lgkmcnt(0)

    s_mov_b32 s8, s4
    s_and_b32 s9, s5, 0xffff
    s_mov_b32 s10, 16777216
    s_mov_b32 s11, 0x00020000
    s_cmp_lg_u32 s12, 0
    s_cbranch_scc1 k2_nozero
    v_lshlrev_b32 v1, 2, v0
    v_add_u32 v1, 131072, v1
    v_mov_b32 v2, 0
    ds_write_b32 v1, v2
    v_and_b32 v1, 1, v0
    v_cmp_eq_u32 vcc, 0, v1
    v_mov_b32 v2, 0x3f803f80
    v_lshlrev_b32 v1, 4, v0
    v_cndmask_b32 v4, 0, v2, vcc
    v_add_u32 v1, 131328, v1
    v_mov_b32 v5, v4
    v_mov_b32 v6, v4
    v_mov_b32 v7, v4
    ds_write_b128 v1, v[4:7]
    s_waitcnt lgkmcnt(0)

k2_nozero:
    s_cmp_lt_u32 s12, 8
    s_cbranch_scc1 k2_attn
    s_barrier
    s_cmp_ge_u32 s2, 43
    s_cbranch_scc1 k2_end
    s_load_dwordx4 s[24:27], s[0:1], 40
    s_load_dwordx2 s[28:29], s[0:1], 56
    s_setprio 2

    v_lshlrev_b32 v1, 7, v0
    s_mov_b32 s30, 10485760
    buffer_load_dwordx4 v[16:19], v1, s[8:11], s30 offen offset:0
    buffer_load_dwordx4 v[20:23], v1, s[8:11], s30 offen offset:16
    buffer_load_dwordx4 v[24:27], v1, s[8:11], s30 offen offset:32
    buffer_load_dwordx4 v[28:31], v1, s[8:11], s30 offen offset:48
    buffer_load_dwordx4 v[32:35], v1, s[8:11], s30 offen offset:64
    buffer_load_dwordx4 v[36:39], v1, s[8:11], s30 offen offset:80
    buffer_load_dwordx4 v[40:43], v1, s[8:11], s30 offen offset:96
    buffer_load_dwordx4 v[44:47], v1, s[8:11], s30 offen offset:112
    s_waitcnt lgkmcnt(0)
    s_mov_b32 s32, s24
    s_and_b32 s33, s25, 0xffff
    s_mov_b32 s34, 1409024
    s_mov_b32 s35, 0x00020000
    s_mov_b32 s36, s26
    s_and_b32 s37, s27, 0xffff
    s_mov_b32 s38, 1409024
    s_mov_b32 s39, 0x00020000
    s_mov_b32 s40, s28
    s_and_b32 s41, s29, 0xffff
    s_mov_b32 s42, 1409024
    s_mov_b32 s43, 0x00020000
    v_lshrrev_b32 v1, 2, v0
    s_movk_i32 s30, 2752
    v_mul_lo_u32 v2, v1, s30
    v_and_b32 v3, 3, v0
    v_lshl_add_u32 v2, v3, 4, v2
    s_lshl_b32 s31, s2, 6
    v_add_u32 v2, s31, v2
    v_mul_u32_u24 v4, 192, v1
    v_lshl_add_u32 v4, v3, 4, v4
    v_add_u32 v4, 132608, v4

    v_add_u32 v12, 0, v2
    buffer_load_dwordx4 v[48:51], v12, s[32:35], 0 offen
    buffer_load_dwordx4 v[52:55], v12, s[36:39], 0 offen
    v_add_u32 v12, 44032, v2
    buffer_load_dwordx4 v[56:59], v12, s[32:35], 0 offen
    buffer_load_dwordx4 v[60:63], v12, s[36:39], 0 offen
    v_add_u32 v12, 88064, v2
    buffer_load_dwordx4 v[64:67], v12, s[32:35], 0 offen
    buffer_load_dwordx4 v[68:71], v12, s[36:39], 0 offen
    v_add_u32 v12, 132096, v2
    buffer_load_dwordx4 v[72:75], v12, s[32:35], 0 offen
    buffer_load_dwordx4 v[76:79], v12, s[36:39], 0 offen
    s_waitcnt vmcnt(8)
    v_max3_u32 v1, v16, v17, v18
    v_max3_u32 v1, v1, v19, v20
    v_max3_u32 v1, v1, v21, v22
    v_max3_u32 v1, v1, v23, v24
    v_max3_u32 v1, v1, v25, v26
    v_max3_u32 v1, v1, v27, v28
    v_max3_u32 v1, v1, v29, v30
    v_max3_u32 v1, v1, v31, v32
    v_max3_u32 v1, v1, v33, v34
    v_max3_u32 v1, v1, v35, v36
    v_max3_u32 v1, v1, v37, v38
    v_max3_u32 v1, v1, v39, v40
    v_max3_u32 v1, v1, v41, v42
    v_max3_u32 v1, v1, v43, v44
    v_max3_u32 v1, v1, v45, v46
    v_max_u32 v1, v1, v47
    s_nop 1
    v_max_u32_dpp v1, v1, v1 row_ror:8 row_mask:0xf bank_mask:0xf
    s_nop 1
    v_max_u32_dpp v1, v1, v1 row_ror:4 row_mask:0xf bank_mask:0xf
    s_nop 1
    v_max_u32_dpp v1, v1, v1 row_ror:2 row_mask:0xf bank_mask:0xf
    s_nop 1
    v_max_u32_dpp v1, v1, v1 row_ror:1 row_mask:0xf bank_mask:0xf
    s_nop 1
    v_readlane_b32 s60, v1, 0
    v_readlane_b32 s61, v1, 16
    v_readlane_b32 s62, v1, 32
    v_readlane_b32 s63, v1, 48
    s_max_u32 s60, s60, s61
    s_max_u32 s62, s62, s63
    s_max_u32 s60, s60, s62
    s_mov_b32 s48, s60
    s_nop 4
    v_subrev_u32 v112, s48, v16
    v_subrev_u32 v113, s48, v17
    v_subrev_u32 v114, s48, v18
    v_subrev_u32 v115, s48, v19
    v_subrev_u32 v116, s48, v20
    v_subrev_u32 v117, s48, v21
    v_subrev_u32 v118, s48, v22
    v_subrev_u32 v119, s48, v23
    v_subrev_u32 v120, s48, v24
    v_subrev_u32 v121, s48, v25
    v_subrev_u32 v122, s48, v26
    v_subrev_u32 v123, s48, v27
    v_subrev_u32 v124, s48, v28
    v_subrev_u32 v125, s48, v29
    v_subrev_u32 v126, s48, v30
    v_subrev_u32 v127, s48, v31
    v_max3_u32 v1, v112, v113, v114
    v_max3_u32 v1, v1, v115, v116
    v_max3_u32 v1, v1, v117, v118
    v_max3_u32 v1, v1, v119, v120
    v_max3_u32 v1, v1, v121, v122
    v_max3_u32 v1, v1, v123, v124
    v_max3_u32 v1, v1, v125, v126
    v_max_u32 v1, v1, v127
    v_subrev_u32 v112, s48, v32
    v_subrev_u32 v113, s48, v33
    v_subrev_u32 v114, s48, v34
    v_subrev_u32 v115, s48, v35
    v_subrev_u32 v116, s48, v36
    v_subrev_u32 v117, s48, v37
    v_subrev_u32 v118, s48, v38
    v_subrev_u32 v119, s48, v39
    v_subrev_u32 v120, s48, v40
    v_subrev_u32 v121, s48, v41
    v_subrev_u32 v122, s48, v42
    v_subrev_u32 v123, s48, v43
    v_subrev_u32 v124, s48, v44
    v_subrev_u32 v125, s48, v45
    v_subrev_u32 v126, s48, v46
    v_subrev_u32 v127, s48, v47
    v_max3_u32 v1, v1, v112, v113
    v_max3_u32 v1, v1, v114, v115
    v_max3_u32 v1, v1, v116, v117
    v_max3_u32 v1, v1, v118, v119
    v_max3_u32 v1, v1, v120, v121
    v_max3_u32 v1, v1, v122, v123
    v_max3_u32 v1, v1, v124, v125
    v_max3_u32 v1, v1, v126, v127
    s_nop 1
    v_max_u32_dpp v1, v1, v1 row_ror:8 row_mask:0xf bank_mask:0xf
    s_nop 1
    v_max_u32_dpp v1, v1, v1 row_ror:4 row_mask:0xf bank_mask:0xf
    s_nop 1
    v_max_u32_dpp v1, v1, v1 row_ror:2 row_mask:0xf bank_mask:0xf
    s_nop 1
    v_max_u32_dpp v1, v1, v1 row_ror:1 row_mask:0xf bank_mask:0xf
    s_nop 1
    v_readlane_b32 s60, v1, 0
    v_readlane_b32 s61, v1, 16
    v_readlane_b32 s62, v1, 32
    v_readlane_b32 s63, v1, 48
    s_max_u32 s60, s60, s61
    s_max_u32 s62, s62, s63
    s_max_u32 s60, s60, s62
    s_add_u32 s49, s60, s48
    s_nop 4
    v_subrev_u32 v112, s49, v16
    v_subrev_u32 v113, s49, v17
    v_subrev_u32 v114, s49, v18
    v_subrev_u32 v115, s49, v19
    v_subrev_u32 v116, s49, v20
    v_subrev_u32 v117, s49, v21
    v_subrev_u32 v118, s49, v22
    v_subrev_u32 v119, s49, v23
    v_subrev_u32 v120, s49, v24
    v_subrev_u32 v121, s49, v25
    v_subrev_u32 v122, s49, v26
    v_subrev_u32 v123, s49, v27
    v_subrev_u32 v124, s49, v28
    v_subrev_u32 v125, s49, v29
    v_subrev_u32 v126, s49, v30
    v_subrev_u32 v127, s49, v31
    v_max3_u32 v1, v112, v113, v114
    v_max3_u32 v1, v1, v115, v116
    v_max3_u32 v1, v1, v117, v118
    v_max3_u32 v1, v1, v119, v120
    v_max3_u32 v1, v1, v121, v122
    v_max3_u32 v1, v1, v123, v124
    v_max3_u32 v1, v1, v125, v126
    v_max_u32 v1, v1, v127
    v_subrev_u32 v112, s49, v32
    v_subrev_u32 v113, s49, v33
    v_subrev_u32 v114, s49, v34
    v_subrev_u32 v115, s49, v35
    v_subrev_u32 v116, s49, v36
    v_subrev_u32 v117, s49, v37
    v_subrev_u32 v118, s49, v38
    v_subrev_u32 v119, s49, v39
    v_subrev_u32 v120, s49, v40
    v_subrev_u32 v121, s49, v41
    v_subrev_u32 v122, s49, v42
    v_subrev_u32 v123, s49, v43
    v_subrev_u32 v124, s49, v44
    v_subrev_u32 v125, s49, v45
    v_subrev_u32 v126, s49, v46
    v_subrev_u32 v127, s49, v47
    v_max3_u32 v1, v1, v112, v113
    v_max3_u32 v1, v1, v114, v115
    v_max3_u32 v1, v1, v116, v117
    v_max3_u32 v1, v1, v118, v119
    v_max3_u32 v1, v1, v120, v121
    v_max3_u32 v1, v1, v122, v123
    v_max3_u32 v1, v1, v124, v125
    v_max3_u32 v1, v1, v126, v127
    s_nop 1
    v_max_u32_dpp v1, v1, v1 row_ror:8 row_mask:0xf bank_mask:0xf
    s_nop 1
    v_max_u32_dpp v1, v1, v1 row_ror:4 row_mask:0xf bank_mask:0xf
    s_nop 1
    v_max_u32_dpp v1, v1, v1 row_ror:2 row_mask:0xf bank_mask:0xf
    s_nop 1
    v_max_u32_dpp v1, v1, v1 row_ror:1 row_mask:0xf bank_mask:0xf
    s_nop 1
    v_readlane_b32 s60, v1, 0
    v_readlane_b32 s61, v1, 16
    v_readlane_b32 s62, v1, 32
    v_readlane_b32 s63, v1, 48
    s_max_u32 s60, s60, s61
    s_max_u32 s62, s62, s63
    s_max_u32 s60, s60, s62
    s_add_u32 s50, s60, s49
    s_nop 4
    v_subrev_u32 v112, s50, v16
    v_subrev_u32 v113, s50, v17
    v_subrev_u32 v114, s50, v18
    v_subrev_u32 v115, s50, v19
    v_subrev_u32 v116, s50, v20
    v_subrev_u32 v117, s50, v21
    v_subrev_u32 v118, s50, v22
    v_subrev_u32 v119, s50, v23
    v_subrev_u32 v120, s50, v24
    v_subrev_u32 v121, s50, v25
    v_subrev_u32 v122, s50, v26
    v_subrev_u32 v123, s50, v27
    v_subrev_u32 v124, s50, v28
    v_subrev_u32 v125, s50, v29
    v_subrev_u32 v126, s50, v30
    v_subrev_u32 v127, s50, v31
    v_max3_u32 v1, v112, v113, v114
    v_max3_u32 v1, v1, v115, v116
    v_max3_u32 v1, v1, v117, v118
    v_max3_u32 v1, v1, v119, v120
    v_max3_u32 v1, v1, v121, v122
    v_max3_u32 v1, v1, v123, v124
    v_max3_u32 v1, v1, v125, v126
    v_max_u32 v1, v1, v127
    v_subrev_u32 v112, s50, v32
    v_subrev_u32 v113, s50, v33
    v_subrev_u32 v114, s50, v34
    v_subrev_u32 v115, s50, v35
    v_subrev_u32 v116, s50, v36
    v_subrev_u32 v117, s50, v37
    v_subrev_u32 v118, s50, v38
    v_subrev_u32 v119, s50, v39
    v_subrev_u32 v120, s50, v40
    v_subrev_u32 v121, s50, v41
    v_subrev_u32 v122, s50, v42
    v_subrev_u32 v123, s50, v43
    v_subrev_u32 v124, s50, v44
    v_subrev_u32 v125, s50, v45
    v_subrev_u32 v126, s50, v46
    v_subrev_u32 v127, s50, v47
    v_max3_u32 v1, v1, v112, v113
    v_max3_u32 v1, v1, v114, v115
    v_max3_u32 v1, v1, v116, v117
    v_max3_u32 v1, v1, v118, v119
    v_max3_u32 v1, v1, v120, v121
    v_max3_u32 v1, v1, v122, v123
    v_max3_u32 v1, v1, v124, v125
    v_max3_u32 v1, v1, v126, v127
    s_nop 1
    v_max_u32_dpp v1, v1, v1 row_ror:8 row_mask:0xf bank_mask:0xf
    s_nop 1
    v_max_u32_dpp v1, v1, v1 row_ror:4 row_mask:0xf bank_mask:0xf
    s_nop 1
    v_max_u32_dpp v1, v1, v1 row_ror:2 row_mask:0xf bank_mask:0xf
    s_nop 1
    v_max_u32_dpp v1, v1, v1 row_ror:1 row_mask:0xf bank_mask:0xf
    s_nop 1
    v_readlane_b32 s60, v1, 0
    v_readlane_b32 s61, v1, 16
    v_readlane_b32 s62, v1, 32
    v_readlane_b32 s63, v1, 48
    s_max_u32 s60, s60, s61
    s_max_u32 s62, s62, s63
    s_max_u32 s60, s60, s62
    s_add_u32 s51, s60, s50
    s_nop 4
    v_subrev_u32 v112, s51, v16
    v_subrev_u32 v113, s51, v17
    v_subrev_u32 v114, s51, v18
    v_subrev_u32 v115, s51, v19
    v_subrev_u32 v116, s51, v20
    v_subrev_u32 v117, s51, v21
    v_subrev_u32 v118, s51, v22
    v_subrev_u32 v119, s51, v23
    v_subrev_u32 v120, s51, v24
    v_subrev_u32 v121, s51, v25
    v_subrev_u32 v122, s51, v26
    v_subrev_u32 v123, s51, v27
    v_subrev_u32 v124, s51, v28
    v_subrev_u32 v125, s51, v29
    v_subrev_u32 v126, s51, v30
    v_subrev_u32 v127, s51, v31
    v_max3_u32 v1, v112, v113, v114
    v_max3_u32 v1, v1, v115, v116
    v_max3_u32 v1, v1, v117, v118
    v_max3_u32 v1, v1, v119, v120
    v_max3_u32 v1, v1, v121, v122
    v_max3_u32 v1, v1, v123, v124
    v_max3_u32 v1, v1, v125, v126
    v_max_u32 v1, v1, v127
    v_subrev_u32 v112, s51, v32
    v_subrev_u32 v113, s51, v33
    v_subrev_u32 v114, s51, v34
    v_subrev_u32 v115, s51, v35
    v_subrev_u32 v116, s51, v36
    v_subrev_u32 v117, s51, v37
    v_subrev_u32 v118, s51, v38
    v_subrev_u32 v119, s51, v39
    v_subrev_u32 v120, s51, v40
    v_subrev_u32 v121, s51, v41
    v_subrev_u32 v122, s51, v42
    v_subrev_u32 v123, s51, v43
    v_subrev_u32 v124, s51, v44
    v_subrev_u32 v125, s51, v45
    v_subrev_u32 v126, s51, v46
    v_subrev_u32 v127, s51, v47
    v_max3_u32 v1, v1, v112, v113
    v_max3_u32 v1, v1, v114, v115
    v_max3_u32 v1, v1, v116, v117
    v_max3_u32 v1, v1, v118, v119
    v_max3_u32 v1, v1, v120, v121
    v_max3_u32 v1, v1, v122, v123
    v_max3_u32 v1, v1, v124, v125
    v_max3_u32 v1, v1, v126, v127
    s_nop 1
    v_max_u32_dpp v1, v1, v1 row_ror:8 row_mask:0xf bank_mask:0xf
    s_nop 1
    v_max_u32_dpp v1, v1, v1 row_ror:4 row_mask:0xf bank_mask:0xf
    s_nop 1
    v_max_u32_dpp v1, v1, v1 row_ror:2 row_mask:0xf bank_mask:0xf
    s_nop 1
    v_max_u32_dpp v1, v1, v1 row_ror:1 row_mask:0xf bank_mask:0xf
    s_nop 1
    v_readlane_b32 s60, v1, 0
    v_readlane_b32 s61, v1, 16
    v_readlane_b32 s62, v1, 32
    v_readlane_b32 s63, v1, 48
    s_max_u32 s60, s60, s61
    s_max_u32 s62, s62, s63
    s_max_u32 s60, s60, s62
    s_add_u32 s52, s60, s51
    s_nop 4
    v_subrev_u32 v112, s52, v16
    v_subrev_u32 v113, s52, v17
    v_subrev_u32 v114, s52, v18
    v_subrev_u32 v115, s52, v19
    v_subrev_u32 v116, s52, v20
    v_subrev_u32 v117, s52, v21
    v_subrev_u32 v118, s52, v22
    v_subrev_u32 v119, s52, v23
    v_subrev_u32 v120, s52, v24
    v_subrev_u32 v121, s52, v25
    v_subrev_u32 v122, s52, v26
    v_subrev_u32 v123, s52, v27
    v_subrev_u32 v124, s52, v28
    v_subrev_u32 v125, s52, v29
    v_subrev_u32 v126, s52, v30
    v_subrev_u32 v127, s52, v31
    v_max3_u32 v1, v112, v113, v114
    v_max3_u32 v1, v1, v115, v116
    v_max3_u32 v1, v1, v117, v118
    v_max3_u32 v1, v1, v119, v120
    v_max3_u32 v1, v1, v121, v122
    v_max3_u32 v1, v1, v123, v124
    v_max3_u32 v1, v1, v125, v126
    v_max_u32 v1, v1, v127
    v_subrev_u32 v112, s52, v32
    v_subrev_u32 v113, s52, v33
    v_subrev_u32 v114, s52, v34
    v_subrev_u32 v115, s52, v35
    v_subrev_u32 v116, s52, v36
    v_subrev_u32 v117, s52, v37
    v_subrev_u32 v118, s52, v38
    v_subrev_u32 v119, s52, v39
    v_subrev_u32 v120, s52, v40
    v_subrev_u32 v121, s52, v41
    v_subrev_u32 v122, s52, v42
    v_subrev_u32 v123, s52, v43
    v_subrev_u32 v124, s52, v44
    v_subrev_u32 v125, s52, v45
    v_subrev_u32 v126, s52, v46
    v_subrev_u32 v127, s52, v47
    v_max3_u32 v1, v1, v112, v113
    v_max3_u32 v1, v1, v114, v115
    v_max3_u32 v1, v1, v116, v117
    v_max3_u32 v1, v1, v118, v119
    v_max3_u32 v1, v1, v120, v121
    v_max3_u32 v1, v1, v122, v123
    v_max3_u32 v1, v1, v124, v125
    v_max3_u32 v1, v1, v126, v127
    s_nop 1
    v_max_u32_dpp v1, v1, v1 row_ror:8 row_mask:0xf bank_mask:0xf
    s_nop 1
    v_max_u32_dpp v1, v1, v1 row_ror:4 row_mask:0xf bank_mask:0xf
    s_nop 1
    v_max_u32_dpp v1, v1, v1 row_ror:2 row_mask:0xf bank_mask:0xf
    s_nop 1
    v_max_u32_dpp v1, v1, v1 row_ror:1 row_mask:0xf bank_mask:0xf
    s_nop 1
    v_readlane_b32 s60, v1, 0
    v_readlane_b32 s61, v1, 16
    v_readlane_b32 s62, v1, 32
    v_readlane_b32 s63, v1, 48
    s_max_u32 s60, s60, s61
    s_max_u32 s62, s62, s63
    s_max_u32 s60, s60, s62
    s_add_u32 s53, s60, s52
    s_nop 4
    v_subrev_u32 v112, s53, v16
    v_subrev_u32 v113, s53, v17
    v_subrev_u32 v114, s53, v18
    v_subrev_u32 v115, s53, v19
    v_subrev_u32 v116, s53, v20
    v_subrev_u32 v117, s53, v21
    v_subrev_u32 v118, s53, v22
    v_subrev_u32 v119, s53, v23
    v_subrev_u32 v120, s53, v24
    v_subrev_u32 v121, s53, v25
    v_subrev_u32 v122, s53, v26
    v_subrev_u32 v123, s53, v27
    v_subrev_u32 v124, s53, v28
    v_subrev_u32 v125, s53, v29
    v_subrev_u32 v126, s53, v30
    v_subrev_u32 v127, s53, v31
    v_max3_u32 v1, v112, v113, v114
    v_max3_u32 v1, v1, v115, v116
    v_max3_u32 v1, v1, v117, v118
    v_max3_u32 v1, v1, v119, v120
    v_max3_u32 v1, v1, v121, v122
    v_max3_u32 v1, v1, v123, v124
    v_max3_u32 v1, v1, v125, v126
    v_max_u32 v1, v1, v127
    v_subrev_u32 v112, s53, v32
    v_subrev_u32 v113, s53, v33
    v_subrev_u32 v114, s53, v34
    v_subrev_u32 v115, s53, v35
    v_subrev_u32 v116, s53, v36
    v_subrev_u32 v117, s53, v37
    v_subrev_u32 v118, s53, v38
    v_subrev_u32 v119, s53, v39
    v_subrev_u32 v120, s53, v40
    v_subrev_u32 v121, s53, v41
    v_subrev_u32 v122, s53, v42
    v_subrev_u32 v123, s53, v43
    v_subrev_u32 v124, s53, v44
    v_subrev_u32 v125, s53, v45
    v_subrev_u32 v126, s53, v46
    v_subrev_u32 v127, s53, v47
    v_max3_u32 v1, v1, v112, v113
    v_max3_u32 v1, v1, v114, v115
    v_max3_u32 v1, v1, v116, v117
    v_max3_u32 v1, v1, v118, v119
    v_max3_u32 v1, v1, v120, v121
    v_max3_u32 v1, v1, v122, v123
    v_max3_u32 v1, v1, v124, v125
    v_max3_u32 v1, v1, v126, v127
    s_nop 1
    v_max_u32_dpp v1, v1, v1 row_ror:8 row_mask:0xf bank_mask:0xf
    s_nop 1
    v_max_u32_dpp v1, v1, v1 row_ror:4 row_mask:0xf bank_mask:0xf
    s_nop 1
    v_max_u32_dpp v1, v1, v1 row_ror:2 row_mask:0xf bank_mask:0xf
    s_nop 1
    v_max_u32_dpp v1, v1, v1 row_ror:1 row_mask:0xf bank_mask:0xf
    s_nop 1
    v_readlane_b32 s60, v1, 0
    v_readlane_b32 s61, v1, 16
    v_readlane_b32 s62, v1, 32
    v_readlane_b32 s63, v1, 48
    s_max_u32 s60, s60, s61
    s_max_u32 s62, s62, s63
    s_max_u32 s60, s60, s62
    s_add_u32 s54, s60, s53
    s_nop 4
    v_subrev_u32 v112, s54, v16
    v_subrev_u32 v113, s54, v17
    v_subrev_u32 v114, s54, v18
    v_subrev_u32 v115, s54, v19
    v_subrev_u32 v116, s54, v20
    v_subrev_u32 v117, s54, v21
    v_subrev_u32 v118, s54, v22
    v_subrev_u32 v119, s54, v23
    v_subrev_u32 v120, s54, v24
    v_subrev_u32 v121, s54, v25
    v_subrev_u32 v122, s54, v26
    v_subrev_u32 v123, s54, v27
    v_subrev_u32 v124, s54, v28
    v_subrev_u32 v125, s54, v29
    v_subrev_u32 v126, s54, v30
    v_subrev_u32 v127, s54, v31
    v_max3_u32 v1, v112, v113, v114
    v_max3_u32 v1, v1, v115, v116
    v_max3_u32 v1, v1, v117, v118
    v_max3_u32 v1, v1, v119, v120
    v_max3_u32 v1, v1, v121, v122
    v_max3_u32 v1, v1, v123, v124
    v_max3_u32 v1, v1, v125, v126
    v_max_u32 v1, v1, v127
    v_subrev_u32 v112, s54, v32
    v_subrev_u32 v113, s54, v33
    v_subrev_u32 v114, s54, v34
    v_subrev_u32 v115, s54, v35
    v_subrev_u32 v116, s54, v36
    v_subrev_u32 v117, s54, v37
    v_subrev_u32 v118, s54, v38
    v_subrev_u32 v119, s54, v39
    v_subrev_u32 v120, s54, v40
    v_subrev_u32 v121, s54, v41
    v_subrev_u32 v122, s54, v42
    v_subrev_u32 v123, s54, v43
    v_subrev_u32 v124, s54, v44
    v_subrev_u32 v125, s54, v45
    v_subrev_u32 v126, s54, v46
    v_subrev_u32 v127, s54, v47
    v_max3_u32 v1, v1, v112, v113
    v_max3_u32 v1, v1, v114, v115
    v_max3_u32 v1, v1, v116, v117
    v_max3_u32 v1, v1, v118, v119
    v_max3_u32 v1, v1, v120, v121
    v_max3_u32 v1, v1, v122, v123
    v_max3_u32 v1, v1, v124, v125
    v_max3_u32 v1, v1, v126, v127
    s_nop 1
    v_max_u32_dpp v1, v1, v1 row_ror:8 row_mask:0xf bank_mask:0xf
    s_nop 1
    v_max_u32_dpp v1, v1, v1 row_ror:4 row_mask:0xf bank_mask:0xf
    s_nop 1
    v_max_u32_dpp v1, v1, v1 row_ror:2 row_mask:0xf bank_mask:0xf
    s_nop 1
    v_max_u32_dpp v1, v1, v1 row_ror:1 row_mask:0xf bank_mask:0xf
    s_nop 1
    v_readlane_b32 s60, v1, 0
    v_readlane_b32 s61, v1, 16
    v_readlane_b32 s62, v1, 32
    v_readlane_b32 s63, v1, 48
    s_max_u32 s60, s60, s61
    s_max_u32 s62, s62, s63
    s_max_u32 s60, s60, s62
    s_add_u32 s55, s60, s54
    s_nop 4
    v_mov_b32 v5, 0
    s_and_b32 s60, s48, 0xffff
    s_sub_u32 s60, 2047, s60
    s_lshl_b32 s61, s60, 10
    v_writelane_b32 v5, s61, 0
    v_writelane_b32 v5, s61, 32
    s_and_b32 s60, s49, 0xffff
    s_sub_u32 s60, 2047, s60
    s_lshl_b32 s61, s60, 10
    v_writelane_b32 v5, s61, 1
    v_writelane_b32 v5, s61, 33
    s_and_b32 s60, s50, 0xffff
    s_sub_u32 s60, 2047, s60
    s_lshl_b32 s61, s60, 10
    v_writelane_b32 v5, s61, 2
    v_writelane_b32 v5, s61, 34
    s_and_b32 s60, s51, 0xffff
    s_sub_u32 s60, 2047, s60
    s_lshl_b32 s61, s60, 10
    v_writelane_b32 v5, s61, 3
    v_writelane_b32 v5, s61, 35
    s_and_b32 s60, s52, 0xffff
    s_sub_u32 s60, 2047, s60
    s_lshl_b32 s61, s60, 10
    v_writelane_b32 v5, s61, 4
    v_writelane_b32 v5, s61, 36
    s_and_b32 s60, s53, 0xffff
    s_sub_u32 s60, 2047, s60
    s_lshl_b32 s61, s60, 10
    v_writelane_b32 v5, s61, 5
    v_writelane_b32 v5, s61, 37
    s_and_b32 s60, s54, 0xffff
    s_sub_u32 s60, 2047, s60
    s_lshl_b32 s61, s60, 10
    v_writelane_b32 v5, s61, 6
    v_writelane_b32 v5, s61, 38
    s_and_b32 s60, s55, 0xffff
    s_sub_u32 s60, 2047, s60
    s_lshl_b32 s61, s60, 10
    v_writelane_b32 v5, s61, 7
    v_writelane_b32 v5, s61, 39
    v_lshrrev_b32 v6, 5, v0
    v_lshl_add_u32 v5, v6, 4, v5

    s_cmp_lg_u32 s2, 0
    s_cbranch_scc1 k2_sksel_9
    v_mov_b32 v7, 0

    v_writelane_b32 v7, s48, 0
    v_writelane_b32 v7, s49, 1
    v_writelane_b32 v7, s50, 2
    v_writelane_b32 v7, s51, 3
    v_writelane_b32 v7, s52, 4
    v_writelane_b32 v7, s53, 5
    v_writelane_b32 v7, s54, 6
    v_writelane_b32 v7, s55, 7
    v_and_b32 v8, 0xffff, v7
    v_sub_u32 v8, 2047, v8
    v_lshrrev_b32 v9, 16, v7
    v_and_b32 v10, 0x8000, v9
    v_cmp_ne_u32 vcc, 0, v10
    v_xor_b32 v10, 0x8000, v9
    v_xor_b32 v11, 0xffff, v9
    s_nop 0
    v_cndmask_b32 v9, v11, v10, vcc
    v_lshlrev_b32 v9, 16, v9
    v_mul_f32 v10, 0xbfb8aa3b, v9
    v_exp_f32 v10, v10
    s_nop 0
    v_add_f32 v10, 1.0, v10
    v_rcp_f32 v10, v10
    s_nop 0
    v_cvt_pk_bf16_f32 v10, 0, v10
    v_lshlrev_b32 v11, 2, v0
    v_cmp_gt_u32 vcc, 8, v0
    s_and_saveexec_b64 s[60:61], vcc
    s_mov_b32 s62, 10616832
    buffer_store_dword v8, v11, s[8:11], s62 offen
    buffer_store_dword v10, v11, s[8:11], s62 offen offset:32
    s_mov_b64 exec, s[60:61]

k2_sksel_9:
    v_mov_b32 v16, 0
    v_mov_b32 v80, 0
    v_mov_b32 v96, 0
    v_mov_b32 v17, 0
    v_mov_b32 v81, 0
    v_mov_b32 v97, 0
    v_mov_b32 v18, 0
    v_mov_b32 v82, 0
    v_mov_b32 v98, 0
    v_mov_b32 v19, 0
    v_mov_b32 v83, 0
    v_mov_b32 v99, 0
    v_mov_b32 v20, 0
    v_mov_b32 v84, 0
    v_mov_b32 v100, 0
    v_mov_b32 v21, 0
    v_mov_b32 v85, 0
    v_mov_b32 v101, 0
    v_mov_b32 v22, 0
    v_mov_b32 v86, 0
    v_mov_b32 v102, 0
    v_mov_b32 v23, 0
    v_mov_b32 v87, 0
    v_mov_b32 v103, 0
    v_mov_b32 v24, 0
    v_mov_b32 v88, 0
    v_mov_b32 v104, 0
    v_mov_b32 v25, 0
    v_mov_b32 v89, 0
    v_mov_b32 v105, 0
    v_mov_b32 v26, 0
    v_mov_b32 v90, 0
    v_mov_b32 v106, 0
    v_mov_b32 v27, 0
    v_mov_b32 v91, 0
    v_mov_b32 v107, 0
    v_mov_b32 v28, 0
    v_mov_b32 v92, 0
    v_mov_b32 v108, 0
    v_mov_b32 v29, 0
    v_mov_b32 v93, 0
    v_mov_b32 v109, 0
    v_mov_b32 v30, 0
    v_mov_b32 v94, 0
    v_mov_b32 v110, 0
    v_mov_b32 v31, 0
    v_mov_b32 v95, 0
    v_mov_b32 v111, 0
    s_mov_b32 s44, 0x000000ff
    s_mov_b32 s45, 0x000000ff
    v_lshrrev_b32 v6, 5, v0
    v_lshlrev_b32 v6, 3, v6
    v_bfe_u32 v7, v0, 2, 2
    v_add_u32 v6, v6, v7
    v_mul_u32_u24 v6, 192, v6
    v_bfe_u32 v7, v0, 4, 1
    v_lshl_add_u32 v6, v7, 5, v6
    v_and_b32 v7, 3, v0
    v_lshl_add_u32 v6, v7, 3, v6
    v_add_u32 v6, 132608, v6

    s_waitcnt vmcnt(0)
    ds_write_b128 v4, v[48:51] offset:0
    ds_write_b128 v4, v[52:55] offset:64
    ds_write_b128 v4, v[56:59] offset:3072
    ds_write_b128 v4, v[60:63] offset:3136
    ds_write_b128 v4, v[64:67] offset:6144
    ds_write_b128 v4, v[68:71] offset:6208
    ds_write_b128 v4, v[72:75] offset:9216
    ds_write_b128 v4, v[76:79] offset:9280
    s_mov_b64 exec, s[44:45]
    buffer_load_dwordx4 v[16:19], v5, s[8:11], 0 offen offset:0
    buffer_load_dwordx4 v[20:23], v5, s[8:11], 0 offen offset:32
    buffer_load_dwordx4 v[24:27], v5, s[8:11], 0 offen offset:64
    buffer_load_dwordx4 v[28:31], v5, s[8:11], 0 offen offset:96
    s_mov_b64 exec, -1
    v_add_u32 v12, 176128, v2
    buffer_load_dwordx4 v[48:51], v12, s[32:35], 0 offen
    buffer_load_dwordx4 v[52:55], v12, s[36:39], 0 offen
    v_add_u32 v12, 220160, v2
    buffer_load_dwordx4 v[56:59], v12, s[32:35], 0 offen
    buffer_load_dwordx4 v[60:63], v12, s[36:39], 0 offen
    v_add_u32 v12, 264192, v2
    buffer_load_dwordx4 v[64:67], v12, s[32:35], 0 offen
    buffer_load_dwordx4 v[68:71], v12, s[36:39], 0 offen
    v_add_u32 v12, 308224, v2
    buffer_load_dwordx4 v[72:75], v12, s[32:35], 0 offen
    buffer_load_dwordx4 v[76:79], v12, s[36:39], 0 offen
    s_waitcnt vmcnt(8) lgkmcnt(0)
    ds_read_b64_tr_b16 v[112:113], v6 offset:0
    ds_read_b64_tr_b16 v[116:117], v6 offset:64
    ds_read_b64_tr_b16 v[114:115], v6 offset:768
    ds_read_b64_tr_b16 v[118:119], v6 offset:832
    s_waitcnt lgkmcnt(0)
    v_mfma_f32_32x32x16_bf16 v[80:95], v[112:115], v[16:19], v[80:95]
    v_mfma_f32_32x32x16_bf16 v[96:111], v[116:119], v[16:19], v[96:111]
    ds_read_b64_tr_b16 v[120:121], v6 offset:3072
    ds_read_b64_tr_b16 v[124:125], v6 offset:3136
    ds_read_b64_tr_b16 v[122:123], v6 offset:3840
    ds_read_b64_tr_b16 v[126:127], v6 offset:3904
    s_waitcnt lgkmcnt(0)
    v_mfma_f32_32x32x16_bf16 v[80:95], v[120:123], v[20:23], v[80:95]
    v_mfma_f32_32x32x16_bf16 v[96:111], v[124:127], v[20:23], v[96:111]
    ds_read_b64_tr_b16 v[112:113], v6 offset:6144
    ds_read_b64_tr_b16 v[116:117], v6 offset:6208
    ds_read_b64_tr_b16 v[114:115], v6 offset:6912
    ds_read_b64_tr_b16 v[118:119], v6 offset:6976
    s_waitcnt lgkmcnt(0)
    v_mfma_f32_32x32x16_bf16 v[80:95], v[112:115], v[24:27], v[80:95]
    v_mfma_f32_32x32x16_bf16 v[96:111], v[116:119], v[24:27], v[96:111]
    ds_read_b64_tr_b16 v[120:121], v6 offset:9216
    ds_read_b64_tr_b16 v[124:125], v6 offset:9280
    ds_read_b64_tr_b16 v[122:123], v6 offset:9984
    ds_read_b64_tr_b16 v[126:127], v6 offset:10048
    s_waitcnt lgkmcnt(0)
    v_mfma_f32_32x32x16_bf16 v[80:95], v[120:123], v[28:31], v[80:95]
    v_mfma_f32_32x32x16_bf16 v[96:111], v[124:127], v[28:31], v[96:111]
    s_waitcnt vmcnt(0)
    ds_write_b128 v4, v[48:51] offset:12288
    ds_write_b128 v4, v[52:55] offset:12352
    ds_write_b128 v4, v[56:59] offset:15360
    ds_write_b128 v4, v[60:63] offset:15424
    ds_write_b128 v4, v[64:67] offset:18432
    ds_write_b128 v4, v[68:71] offset:18496
    ds_write_b128 v4, v[72:75] offset:21504
    ds_write_b128 v4, v[76:79] offset:21568
    s_mov_b64 exec, s[44:45]
    buffer_load_dwordx4 v[16:19], v5, s[8:11], 0 offen offset:128
    buffer_load_dwordx4 v[20:23], v5, s[8:11], 0 offen offset:160
    buffer_load_dwordx4 v[24:27], v5, s[8:11], 0 offen offset:192
    buffer_load_dwordx4 v[28:31], v5, s[8:11], 0 offen offset:224
    s_mov_b64 exec, -1
    v_add_u32 v12, 352256, v2
    buffer_load_dwordx4 v[48:51], v12, s[32:35], 0 offen
    buffer_load_dwordx4 v[52:55], v12, s[36:39], 0 offen
    v_add_u32 v12, 396288, v2
    buffer_load_dwordx4 v[56:59], v12, s[32:35], 0 offen
    buffer_load_dwordx4 v[60:63], v12, s[36:39], 0 offen
    v_add_u32 v12, 440320, v2
    buffer_load_dwordx4 v[64:67], v12, s[32:35], 0 offen
    buffer_load_dwordx4 v[68:71], v12, s[36:39], 0 offen
    v_add_u32 v12, 484352, v2
    buffer_load_dwordx4 v[72:75], v12, s[32:35], 0 offen
    buffer_load_dwordx4 v[76:79], v12, s[36:39], 0 offen
    s_waitcnt vmcnt(8) lgkmcnt(0)
    ds_read_b64_tr_b16 v[112:113], v6 offset:12288
    ds_read_b64_tr_b16 v[116:117], v6 offset:12352
    ds_read_b64_tr_b16 v[114:115], v6 offset:13056
    ds_read_b64_tr_b16 v[118:119], v6 offset:13120
    s_waitcnt lgkmcnt(0)
    v_mfma_f32_32x32x16_bf16 v[80:95], v[112:115], v[16:19], v[80:95]
    v_mfma_f32_32x32x16_bf16 v[96:111], v[116:119], v[16:19], v[96:111]
    ds_read_b64_tr_b16 v[120:121], v6 offset:15360
    ds_read_b64_tr_b16 v[124:125], v6 offset:15424
    ds_read_b64_tr_b16 v[122:123], v6 offset:16128
    ds_read_b64_tr_b16 v[126:127], v6 offset:16192
    s_waitcnt lgkmcnt(0)
    v_mfma_f32_32x32x16_bf16 v[80:95], v[120:123], v[20:23], v[80:95]
    v_mfma_f32_32x32x16_bf16 v[96:111], v[124:127], v[20:23], v[96:111]
    ds_read_b64_tr_b16 v[112:113], v6 offset:18432
    ds_read_b64_tr_b16 v[116:117], v6 offset:18496
    ds_read_b64_tr_b16 v[114:115], v6 offset:19200
    ds_read_b64_tr_b16 v[118:119], v6 offset:19264
    s_waitcnt lgkmcnt(0)
    v_mfma_f32_32x32x16_bf16 v[80:95], v[112:115], v[24:27], v[80:95]
    v_mfma_f32_32x32x16_bf16 v[96:111], v[116:119], v[24:27], v[96:111]
    ds_read_b64_tr_b16 v[120:121], v6 offset:21504
    ds_read_b64_tr_b16 v[124:125], v6 offset:21568
    ds_read_b64_tr_b16 v[122:123], v6 offset:22272
    ds_read_b64_tr_b16 v[126:127], v6 offset:22336
    s_waitcnt lgkmcnt(0)
    v_mfma_f32_32x32x16_bf16 v[80:95], v[120:123], v[28:31], v[80:95]
    v_mfma_f32_32x32x16_bf16 v[96:111], v[124:127], v[28:31], v[96:111]
    s_waitcnt vmcnt(0)
    ds_write_b128 v4, v[48:51] offset:0
    ds_write_b128 v4, v[52:55] offset:64
    ds_write_b128 v4, v[56:59] offset:3072
    ds_write_b128 v4, v[60:63] offset:3136
    ds_write_b128 v4, v[64:67] offset:6144
    ds_write_b128 v4, v[68:71] offset:6208
    ds_write_b128 v4, v[72:75] offset:9216
    ds_write_b128 v4, v[76:79] offset:9280
    s_mov_b64 exec, s[44:45]
    buffer_load_dwordx4 v[16:19], v5, s[8:11], 0 offen offset:256
    buffer_load_dwordx4 v[20:23], v5, s[8:11], 0 offen offset:288
    buffer_load_dwordx4 v[24:27], v5, s[8:11], 0 offen offset:320
    buffer_load_dwordx4 v[28:31], v5, s[8:11], 0 offen offset:352
    s_mov_b64 exec, -1
    v_add_u32 v12, 528384, v2
    buffer_load_dwordx4 v[48:51], v12, s[32:35], 0 offen
    buffer_load_dwordx4 v[52:55], v12, s[36:39], 0 offen
    v_add_u32 v12, 572416, v2
    buffer_load_dwordx4 v[56:59], v12, s[32:35], 0 offen
    buffer_load_dwordx4 v[60:63], v12, s[36:39], 0 offen
    v_add_u32 v12, 616448, v2
    buffer_load_dwordx4 v[64:67], v12, s[32:35], 0 offen
    buffer_load_dwordx4 v[68:71], v12, s[36:39], 0 offen
    v_add_u32 v12, 660480, v2
    buffer_load_dwordx4 v[72:75], v12, s[32:35], 0 offen
    buffer_load_dwordx4 v[76:79], v12, s[36:39], 0 offen
    s_waitcnt vmcnt(8) lgkmcnt(0)
    ds_read_b64_tr_b16 v[112:113], v6 offset:0
    ds_read_b64_tr_b16 v[116:117], v6 offset:64
    ds_read_b64_tr_b16 v[114:115], v6 offset:768
    ds_read_b64_tr_b16 v[118:119], v6 offset:832
    s_waitcnt lgkmcnt(0)
    v_mfma_f32_32x32x16_bf16 v[80:95], v[112:115], v[16:19], v[80:95]
    v_mfma_f32_32x32x16_bf16 v[96:111], v[116:119], v[16:19], v[96:111]
    ds_read_b64_tr_b16 v[120:121], v6 offset:3072
    ds_read_b64_tr_b16 v[124:125], v6 offset:3136
    ds_read_b64_tr_b16 v[122:123], v6 offset:3840
    ds_read_b64_tr_b16 v[126:127], v6 offset:3904
    s_waitcnt lgkmcnt(0)
    v_mfma_f32_32x32x16_bf16 v[80:95], v[120:123], v[20:23], v[80:95]
    v_mfma_f32_32x32x16_bf16 v[96:111], v[124:127], v[20:23], v[96:111]
    ds_read_b64_tr_b16 v[112:113], v6 offset:6144
    ds_read_b64_tr_b16 v[116:117], v6 offset:6208
    ds_read_b64_tr_b16 v[114:115], v6 offset:6912
    ds_read_b64_tr_b16 v[118:119], v6 offset:6976
    s_waitcnt lgkmcnt(0)
    v_mfma_f32_32x32x16_bf16 v[80:95], v[112:115], v[24:27], v[80:95]
    v_mfma_f32_32x32x16_bf16 v[96:111], v[116:119], v[24:27], v[96:111]
    ds_read_b64_tr_b16 v[120:121], v6 offset:9216
    ds_read_b64_tr_b16 v[124:125], v6 offset:9280
    ds_read_b64_tr_b16 v[122:123], v6 offset:9984
    ds_read_b64_tr_b16 v[126:127], v6 offset:10048
    s_waitcnt lgkmcnt(0)
    v_mfma_f32_32x32x16_bf16 v[80:95], v[120:123], v[28:31], v[80:95]
    v_mfma_f32_32x32x16_bf16 v[96:111], v[124:127], v[28:31], v[96:111]
    s_waitcnt vmcnt(0)
    ds_write_b128 v4, v[48:51] offset:12288
    ds_write_b128 v4, v[52:55] offset:12352
    ds_write_b128 v4, v[56:59] offset:15360
    ds_write_b128 v4, v[60:63] offset:15424
    ds_write_b128 v4, v[64:67] offset:18432
    ds_write_b128 v4, v[68:71] offset:18496
    ds_write_b128 v4, v[72:75] offset:21504
    ds_write_b128 v4, v[76:79] offset:21568
    s_mov_b64 exec, s[44:45]
    buffer_load_dwordx4 v[16:19], v5, s[8:11], 0 offen offset:384
    buffer_load_dwordx4 v[20:23], v5, s[8:11], 0 offen offset:416
    buffer_load_dwordx4 v[24:27], v5, s[8:11], 0 offen offset:448
    buffer_load_dwordx4 v[28:31], v5, s[8:11], 0 offen offset:480
    s_mov_b64 exec, -1
    v_add_u32 v12, 704512, v2
    buffer_load_dwordx4 v[48:51], v12, s[32:35], 0 offen
    buffer_load_dwordx4 v[52:55], v12, s[36:39], 0 offen
    v_add_u32 v12, 748544, v2
    buffer_load_dwordx4 v[56:59], v12, s[32:35], 0 offen
    buffer_load_dwordx4 v[60:63], v12, s[36:39], 0 offen
    v_add_u32 v12, 792576, v2
    buffer_load_dwordx4 v[64:67], v12, s[32:35], 0 offen
    buffer_load_dwordx4 v[68:71], v12, s[36:39], 0 offen
    v_add_u32 v12, 836608, v2
    buffer_load_dwordx4 v[72:75], v12, s[32:35], 0 offen
    buffer_load_dwordx4 v[76:79], v12, s[36:39], 0 offen
    s_waitcnt vmcnt(8) lgkmcnt(0)
    ds_read_b64_tr_b16 v[112:113], v6 offset:12288
    ds_read_b64_tr_b16 v[116:117], v6 offset:12352
    ds_read_b64_tr_b16 v[114:115], v6 offset:13056
    ds_read_b64_tr_b16 v[118:119], v6 offset:13120
    s_waitcnt lgkmcnt(0)
    v_mfma_f32_32x32x16_bf16 v[80:95], v[112:115], v[16:19], v[80:95]
    v_mfma_f32_32x32x16_bf16 v[96:111], v[116:119], v[16:19], v[96:111]
    ds_read_b64_tr_b16 v[120:121], v6 offset:15360
    ds_read_b64_tr_b16 v[124:125], v6 offset:15424
    ds_read_b64_tr_b16 v[122:123], v6 offset:16128
    ds_read_b64_tr_b16 v[126:127], v6 offset:16192
    s_waitcnt lgkmcnt(0)
    v_mfma_f32_32x32x16_bf16 v[80:95], v[120:123], v[20:23], v[80:95]
    v_mfma_f32_32x32x16_bf16 v[96:111], v[124:127], v[20:23], v[96:111]
    ds_read_b64_tr_b16 v[112:113], v6 offset:18432
    ds_read_b64_tr_b16 v[116:117], v6 offset:18496
    ds_read_b64_tr_b16 v[114:115], v6 offset:19200
    ds_read_b64_tr_b16 v[118:119], v6 offset:19264
    s_waitcnt lgkmcnt(0)
    v_mfma_f32_32x32x16_bf16 v[80:95], v[112:115], v[24:27], v[80:95]
    v_mfma_f32_32x32x16_bf16 v[96:111], v[116:119], v[24:27], v[96:111]
    ds_read_b64_tr_b16 v[120:121], v6 offset:21504
    ds_read_b64_tr_b16 v[124:125], v6 offset:21568
    ds_read_b64_tr_b16 v[122:123], v6 offset:22272
    ds_read_b64_tr_b16 v[126:127], v6 offset:22336
    s_waitcnt lgkmcnt(0)
    v_mfma_f32_32x32x16_bf16 v[80:95], v[120:123], v[28:31], v[80:95]
    v_mfma_f32_32x32x16_bf16 v[96:111], v[124:127], v[28:31], v[96:111]
    s_waitcnt vmcnt(0)
    ds_write_b128 v4, v[48:51] offset:0
    ds_write_b128 v4, v[52:55] offset:64
    ds_write_b128 v4, v[56:59] offset:3072
    ds_write_b128 v4, v[60:63] offset:3136
    ds_write_b128 v4, v[64:67] offset:6144
    ds_write_b128 v4, v[68:71] offset:6208
    ds_write_b128 v4, v[72:75] offset:9216
    ds_write_b128 v4, v[76:79] offset:9280
    s_mov_b64 exec, s[44:45]
    buffer_load_dwordx4 v[16:19], v5, s[8:11], 0 offen offset:512
    buffer_load_dwordx4 v[20:23], v5, s[8:11], 0 offen offset:544
    buffer_load_dwordx4 v[24:27], v5, s[8:11], 0 offen offset:576
    buffer_load_dwordx4 v[28:31], v5, s[8:11], 0 offen offset:608
    s_mov_b64 exec, -1
    v_add_u32 v12, 880640, v2
    buffer_load_dwordx4 v[48:51], v12, s[32:35], 0 offen
    buffer_load_dwordx4 v[52:55], v12, s[36:39], 0 offen
    v_add_u32 v12, 924672, v2
    buffer_load_dwordx4 v[56:59], v12, s[32:35], 0 offen
    buffer_load_dwordx4 v[60:63], v12, s[36:39], 0 offen
    v_add_u32 v12, 968704, v2
    buffer_load_dwordx4 v[64:67], v12, s[32:35], 0 offen
    buffer_load_dwordx4 v[68:71], v12, s[36:39], 0 offen
    v_add_u32 v12, 1012736, v2
    buffer_load_dwordx4 v[72:75], v12, s[32:35], 0 offen
    buffer_load_dwordx4 v[76:79], v12, s[36:39], 0 offen
    s_waitcnt vmcnt(8) lgkmcnt(0)
    ds_read_b64_tr_b16 v[112:113], v6 offset:0
    ds_read_b64_tr_b16 v[116:117], v6 offset:64
    ds_read_b64_tr_b16 v[114:115], v6 offset:768
    ds_read_b64_tr_b16 v[118:119], v6 offset:832
    s_waitcnt lgkmcnt(0)
    v_mfma_f32_32x32x16_bf16 v[80:95], v[112:115], v[16:19], v[80:95]
    v_mfma_f32_32x32x16_bf16 v[96:111], v[116:119], v[16:19], v[96:111]
    ds_read_b64_tr_b16 v[120:121], v6 offset:3072
    ds_read_b64_tr_b16 v[124:125], v6 offset:3136
    ds_read_b64_tr_b16 v[122:123], v6 offset:3840
    ds_read_b64_tr_b16 v[126:127], v6 offset:3904
    s_waitcnt lgkmcnt(0)
    v_mfma_f32_32x32x16_bf16 v[80:95], v[120:123], v[20:23], v[80:95]
    v_mfma_f32_32x32x16_bf16 v[96:111], v[124:127], v[20:23], v[96:111]
    ds_read_b64_tr_b16 v[112:113], v6 offset:6144
    ds_read_b64_tr_b16 v[116:117], v6 offset:6208
    ds_read_b64_tr_b16 v[114:115], v6 offset:6912
    ds_read_b64_tr_b16 v[118:119], v6 offset:6976
    s_waitcnt lgkmcnt(0)
    v_mfma_f32_32x32x16_bf16 v[80:95], v[112:115], v[24:27], v[80:95]
    v_mfma_f32_32x32x16_bf16 v[96:111], v[116:119], v[24:27], v[96:111]
    ds_read_b64_tr_b16 v[120:121], v6 offset:9216
    ds_read_b64_tr_b16 v[124:125], v6 offset:9280
    ds_read_b64_tr_b16 v[122:123], v6 offset:9984
    ds_read_b64_tr_b16 v[126:127], v6 offset:10048
    s_waitcnt lgkmcnt(0)
    v_mfma_f32_32x32x16_bf16 v[80:95], v[120:123], v[28:31], v[80:95]
    v_mfma_f32_32x32x16_bf16 v[96:111], v[124:127], v[28:31], v[96:111]
    s_waitcnt vmcnt(0)
    ds_write_b128 v4, v[48:51] offset:12288
    ds_write_b128 v4, v[52:55] offset:12352
    ds_write_b128 v4, v[56:59] offset:15360
    ds_write_b128 v4, v[60:63] offset:15424
    ds_write_b128 v4, v[64:67] offset:18432
    ds_write_b128 v4, v[68:71] offset:18496
    ds_write_b128 v4, v[72:75] offset:21504
    ds_write_b128 v4, v[76:79] offset:21568
    s_mov_b64 exec, s[44:45]
    buffer_load_dwordx4 v[16:19], v5, s[8:11], 0 offen offset:640
    buffer_load_dwordx4 v[20:23], v5, s[8:11], 0 offen offset:672
    buffer_load_dwordx4 v[24:27], v5, s[8:11], 0 offen offset:704
    buffer_load_dwordx4 v[28:31], v5, s[8:11], 0 offen offset:736
    s_mov_b64 exec, -1
    v_add_u32 v12, 1056768, v2
    buffer_load_dwordx4 v[48:51], v12, s[32:35], 0 offen
    buffer_load_dwordx4 v[52:55], v12, s[36:39], 0 offen
    v_add_u32 v12, 1100800, v2
    buffer_load_dwordx4 v[56:59], v12, s[32:35], 0 offen
    buffer_load_dwordx4 v[60:63], v12, s[36:39], 0 offen
    v_add_u32 v12, 1144832, v2
    buffer_load_dwordx4 v[64:67], v12, s[32:35], 0 offen
    buffer_load_dwordx4 v[68:71], v12, s[36:39], 0 offen
    v_add_u32 v12, 1188864, v2
    buffer_load_dwordx4 v[72:75], v12, s[32:35], 0 offen
    buffer_load_dwordx4 v[76:79], v12, s[36:39], 0 offen
    s_waitcnt vmcnt(8) lgkmcnt(0)
    ds_read_b64_tr_b16 v[112:113], v6 offset:12288
    ds_read_b64_tr_b16 v[116:117], v6 offset:12352
    ds_read_b64_tr_b16 v[114:115], v6 offset:13056
    ds_read_b64_tr_b16 v[118:119], v6 offset:13120
    s_waitcnt lgkmcnt(0)
    v_mfma_f32_32x32x16_bf16 v[80:95], v[112:115], v[16:19], v[80:95]
    v_mfma_f32_32x32x16_bf16 v[96:111], v[116:119], v[16:19], v[96:111]
    ds_read_b64_tr_b16 v[120:121], v6 offset:15360
    ds_read_b64_tr_b16 v[124:125], v6 offset:15424
    ds_read_b64_tr_b16 v[122:123], v6 offset:16128
    ds_read_b64_tr_b16 v[126:127], v6 offset:16192
    s_waitcnt lgkmcnt(0)
    v_mfma_f32_32x32x16_bf16 v[80:95], v[120:123], v[20:23], v[80:95]
    v_mfma_f32_32x32x16_bf16 v[96:111], v[124:127], v[20:23], v[96:111]
    ds_read_b64_tr_b16 v[112:113], v6 offset:18432
    ds_read_b64_tr_b16 v[116:117], v6 offset:18496
    ds_read_b64_tr_b16 v[114:115], v6 offset:19200
    ds_read_b64_tr_b16 v[118:119], v6 offset:19264
    s_waitcnt lgkmcnt(0)
    v_mfma_f32_32x32x16_bf16 v[80:95], v[112:115], v[24:27], v[80:95]
    v_mfma_f32_32x32x16_bf16 v[96:111], v[116:119], v[24:27], v[96:111]
    ds_read_b64_tr_b16 v[120:121], v6 offset:21504
    ds_read_b64_tr_b16 v[124:125], v6 offset:21568
    ds_read_b64_tr_b16 v[122:123], v6 offset:22272
    ds_read_b64_tr_b16 v[126:127], v6 offset:22336
    s_waitcnt lgkmcnt(0)
    v_mfma_f32_32x32x16_bf16 v[80:95], v[120:123], v[28:31], v[80:95]
    v_mfma_f32_32x32x16_bf16 v[96:111], v[124:127], v[28:31], v[96:111]
    s_waitcnt vmcnt(0)
    ds_write_b128 v4, v[48:51] offset:0
    ds_write_b128 v4, v[52:55] offset:64
    ds_write_b128 v4, v[56:59] offset:3072
    ds_write_b128 v4, v[60:63] offset:3136
    ds_write_b128 v4, v[64:67] offset:6144
    ds_write_b128 v4, v[68:71] offset:6208
    ds_write_b128 v4, v[72:75] offset:9216
    ds_write_b128 v4, v[76:79] offset:9280
    s_mov_b64 exec, s[44:45]
    buffer_load_dwordx4 v[16:19], v5, s[8:11], 0 offen offset:768
    buffer_load_dwordx4 v[20:23], v5, s[8:11], 0 offen offset:800
    buffer_load_dwordx4 v[24:27], v5, s[8:11], 0 offen offset:832
    buffer_load_dwordx4 v[28:31], v5, s[8:11], 0 offen offset:864
    s_mov_b64 exec, -1
    v_add_u32 v12, 1232896, v2
    buffer_load_dwordx4 v[48:51], v12, s[32:35], 0 offen
    buffer_load_dwordx4 v[52:55], v12, s[36:39], 0 offen
    v_add_u32 v12, 1276928, v2
    buffer_load_dwordx4 v[56:59], v12, s[32:35], 0 offen
    buffer_load_dwordx4 v[60:63], v12, s[36:39], 0 offen
    v_add_u32 v12, 1320960, v2
    buffer_load_dwordx4 v[64:67], v12, s[32:35], 0 offen
    buffer_load_dwordx4 v[68:71], v12, s[36:39], 0 offen
    v_add_u32 v12, 1364992, v2
    buffer_load_dwordx4 v[72:75], v12, s[32:35], 0 offen
    buffer_load_dwordx4 v[76:79], v12, s[36:39], 0 offen
    s_waitcnt vmcnt(8) lgkmcnt(0)
    ds_read_b64_tr_b16 v[112:113], v6 offset:0
    ds_read_b64_tr_b16 v[116:117], v6 offset:64
    ds_read_b64_tr_b16 v[114:115], v6 offset:768
    ds_read_b64_tr_b16 v[118:119], v6 offset:832
    s_waitcnt lgkmcnt(0)
    v_mfma_f32_32x32x16_bf16 v[80:95], v[112:115], v[16:19], v[80:95]
    v_mfma_f32_32x32x16_bf16 v[96:111], v[116:119], v[16:19], v[96:111]
    ds_read_b64_tr_b16 v[120:121], v6 offset:3072
    ds_read_b64_tr_b16 v[124:125], v6 offset:3136
    ds_read_b64_tr_b16 v[122:123], v6 offset:3840
    ds_read_b64_tr_b16 v[126:127], v6 offset:3904
    s_waitcnt lgkmcnt(0)
    v_mfma_f32_32x32x16_bf16 v[80:95], v[120:123], v[20:23], v[80:95]
    v_mfma_f32_32x32x16_bf16 v[96:111], v[124:127], v[20:23], v[96:111]
    ds_read_b64_tr_b16 v[112:113], v6 offset:6144
    ds_read_b64_tr_b16 v[116:117], v6 offset:6208
    ds_read_b64_tr_b16 v[114:115], v6 offset:6912
    ds_read_b64_tr_b16 v[118:119], v6 offset:6976
    s_waitcnt lgkmcnt(0)
    v_mfma_f32_32x32x16_bf16 v[80:95], v[112:115], v[24:27], v[80:95]
    v_mfma_f32_32x32x16_bf16 v[96:111], v[116:119], v[24:27], v[96:111]
    ds_read_b64_tr_b16 v[120:121], v6 offset:9216
    ds_read_b64_tr_b16 v[124:125], v6 offset:9280
    ds_read_b64_tr_b16 v[122:123], v6 offset:9984
    ds_read_b64_tr_b16 v[126:127], v6 offset:10048
    s_waitcnt lgkmcnt(0)
    v_mfma_f32_32x32x16_bf16 v[80:95], v[120:123], v[28:31], v[80:95]
    v_mfma_f32_32x32x16_bf16 v[96:111], v[124:127], v[28:31], v[96:111]
    s_waitcnt vmcnt(0)
    ds_write_b128 v4, v[48:51] offset:12288
    ds_write_b128 v4, v[52:55] offset:12352
    ds_write_b128 v4, v[56:59] offset:15360
    ds_write_b128 v4, v[60:63] offset:15424
    ds_write_b128 v4, v[64:67] offset:18432
    ds_write_b128 v4, v[68:71] offset:18496
    ds_write_b128 v4, v[72:75] offset:21504
    ds_write_b128 v4, v[76:79] offset:21568
    s_mov_b64 exec, s[44:45]
    buffer_load_dwordx4 v[16:19], v5, s[8:11], 0 offen offset:896
    buffer_load_dwordx4 v[20:23], v5, s[8:11], 0 offen offset:928
    buffer_load_dwordx4 v[24:27], v5, s[8:11], 0 offen offset:960
    buffer_load_dwordx4 v[28:31], v5, s[8:11], 0 offen offset:992
    s_mov_b64 exec, -1
    s_waitcnt vmcnt(0) lgkmcnt(0)
    ds_read_b64_tr_b16 v[112:113], v6 offset:12288
    ds_read_b64_tr_b16 v[116:117], v6 offset:12352
    ds_read_b64_tr_b16 v[114:115], v6 offset:13056
    ds_read_b64_tr_b16 v[118:119], v6 offset:13120
    s_waitcnt lgkmcnt(0)
    v_mfma_f32_32x32x16_bf16 v[80:95], v[112:115], v[16:19], v[80:95]
    v_mfma_f32_32x32x16_bf16 v[96:111], v[116:119], v[16:19], v[96:111]
    ds_read_b64_tr_b16 v[120:121], v6 offset:15360
    ds_read_b64_tr_b16 v[124:125], v6 offset:15424
    ds_read_b64_tr_b16 v[122:123], v6 offset:16128
    ds_read_b64_tr_b16 v[126:127], v6 offset:16192
    s_waitcnt lgkmcnt(0)
    v_mfma_f32_32x32x16_bf16 v[80:95], v[120:123], v[20:23], v[80:95]
    v_mfma_f32_32x32x16_bf16 v[96:111], v[124:127], v[20:23], v[96:111]
    ds_read_b64_tr_b16 v[112:113], v6 offset:18432
    ds_read_b64_tr_b16 v[116:117], v6 offset:18496
    ds_read_b64_tr_b16 v[114:115], v6 offset:19200
    ds_read_b64_tr_b16 v[118:119], v6 offset:19264
    s_waitcnt lgkmcnt(0)
    v_mfma_f32_32x32x16_bf16 v[80:95], v[112:115], v[24:27], v[80:95]
    v_mfma_f32_32x32x16_bf16 v[96:111], v[116:119], v[24:27], v[96:111]
    ds_read_b64_tr_b16 v[120:121], v6 offset:21504
    ds_read_b64_tr_b16 v[124:125], v6 offset:21568
    ds_read_b64_tr_b16 v[122:123], v6 offset:22272
    ds_read_b64_tr_b16 v[126:127], v6 offset:22336
    s_waitcnt lgkmcnt(0)
    v_mfma_f32_32x32x16_bf16 v[80:95], v[120:123], v[28:31], v[80:95]
    v_mfma_f32_32x32x16_bf16 v[96:111], v[124:127], v[28:31], v[96:111]
    v_lshrrev_b32 v1, 5, v0
    s_lshl_b32 s31, s2, 5
    v_add_u32 v1, s31, v1
    v_lshlrev_b32 v1, 10, v1
    v_and_b32 v2, 31, v0
    v_lshl_add_u32 v1, v2, 4, v1
    v_lshrrev_b32 v3, 5, v0
    v_mul_u32_u24 v3, 576, v3
    v_lshl_add_u32 v3, v2, 4, v3
    v_add_u32 v3, 132608, v3

    v_add_u32 v4, 0, v1
    buffer_load_dwordx4 v[16:19], v4, s[40:43], 0 offen offset:0
    v_add_u32 v4, 2048, v1
    buffer_load_dwordx4 v[20:23], v4, s[40:43], 0 offen offset:0
    v_add_u32 v4, 4096, v1
    buffer_load_dwordx4 v[24:27], v4, s[40:43], 0 offen offset:0
    v_add_u32 v4, 6144, v1
    buffer_load_dwordx4 v[28:31], v4, s[40:43], 0 offen offset:0
    v_add_u32 v4, 8192, v1
    buffer_load_dwordx4 v[32:35], v4, s[40:43], 0 offen offset:0
    v_add_u32 v4, 10240, v1
    buffer_load_dwordx4 v[36:39], v4, s[40:43], 0 offen offset:0
    v_add_u32 v4, 12288, v1
    buffer_load_dwordx4 v[40:43], v4, s[40:43], 0 offen offset:0
    v_add_u32 v4, 14336, v1
    buffer_load_dwordx4 v[44:47], v4, s[40:43], 0 offen offset:0
    v_add_u32 v4, 16384, v1
    buffer_load_dwordx4 v[48:51], v4, s[40:43], 0 offen offset:0
    v_add_u32 v4, 18432, v1
    buffer_load_dwordx4 v[52:55], v4, s[40:43], 0 offen offset:0
    v_add_u32 v4, 20480, v1
    buffer_load_dwordx4 v[56:59], v4, s[40:43], 0 offen offset:0
    v_add_u32 v4, 22528, v1
    buffer_load_dwordx4 v[60:63], v4, s[40:43], 0 offen offset:0
    v_add_u32 v4, 24576, v1
    buffer_load_dwordx4 v[64:67], v4, s[40:43], 0 offen offset:0
    v_add_u32 v4, 26624, v1
    buffer_load_dwordx4 v[68:71], v4, s[40:43], 0 offen offset:0
    v_add_u32 v4, 28672, v1
    buffer_load_dwordx4 v[72:75], v4, s[40:43], 0 offen offset:0
    v_add_u32 v4, 30720, v1
    buffer_load_dwordx4 v[76:79], v4, s[40:43], 0 offen offset:0
    s_nop 7
    v_cvt_pk_bf16_f32 v80, 0, v80
    v_cvt_pk_bf16_f32 v96, 0, v96
    v_cvt_pk_bf16_f32 v81, 0, v81
    v_cvt_pk_bf16_f32 v97, 0, v97
    v_cvt_pk_bf16_f32 v82, 0, v82
    v_cvt_pk_bf16_f32 v98, 0, v98
    v_cvt_pk_bf16_f32 v83, 0, v83
    v_cvt_pk_bf16_f32 v99, 0, v99
    v_cvt_pk_bf16_f32 v84, 0, v84
    v_cvt_pk_bf16_f32 v100, 0, v100
    v_cvt_pk_bf16_f32 v85, 0, v85
    v_cvt_pk_bf16_f32 v101, 0, v101
    v_cvt_pk_bf16_f32 v86, 0, v86
    v_cvt_pk_bf16_f32 v102, 0, v102
    v_cvt_pk_bf16_f32 v87, 0, v87
    v_cvt_pk_bf16_f32 v103, 0, v103
    v_cvt_pk_bf16_f32 v88, 0, v88
    v_cvt_pk_bf16_f32 v104, 0, v104
    v_cvt_pk_bf16_f32 v89, 0, v89
    v_cvt_pk_bf16_f32 v105, 0, v105
    v_cvt_pk_bf16_f32 v90, 0, v90
    v_cvt_pk_bf16_f32 v106, 0, v106
    v_cvt_pk_bf16_f32 v91, 0, v91
    v_cvt_pk_bf16_f32 v107, 0, v107
    v_cvt_pk_bf16_f32 v92, 0, v92
    v_cvt_pk_bf16_f32 v108, 0, v108
    v_cvt_pk_bf16_f32 v93, 0, v93
    v_cvt_pk_bf16_f32 v109, 0, v109
    v_cvt_pk_bf16_f32 v94, 0, v94
    v_cvt_pk_bf16_f32 v110, 0, v110
    v_cvt_pk_bf16_f32 v95, 0, v95
    v_cvt_pk_bf16_f32 v111, 0, v111
    v_mul_f32 v120, 0xbfb8aa3b, v80
    v_mul_f32 v121, 0xbfb8aa3b, v81
    v_mul_f32 v122, 0xbfb8aa3b, v82
    v_mul_f32 v123, 0xbfb8aa3b, v83
    v_mul_f32 v124, 0xbfb8aa3b, v84
    v_mul_f32 v125, 0xbfb8aa3b, v85
    v_mul_f32 v126, 0xbfb8aa3b, v86
    v_mul_f32 v127, 0xbfb8aa3b, v87
    v_exp_f32 v120, v120
    v_exp_f32 v121, v121
    v_exp_f32 v122, v122
    v_exp_f32 v123, v123
    v_exp_f32 v124, v124
    v_exp_f32 v125, v125
    v_exp_f32 v126, v126
    v_exp_f32 v127, v127
    v_add_f32 v120, 1.0, v120
    v_add_f32 v121, 1.0, v121
    v_add_f32 v122, 1.0, v122
    v_add_f32 v123, 1.0, v123
    v_add_f32 v124, 1.0, v124
    v_add_f32 v125, 1.0, v125
    v_add_f32 v126, 1.0, v126
    v_add_f32 v127, 1.0, v127
    v_rcp_f32 v120, v120
    v_rcp_f32 v121, v121
    v_rcp_f32 v122, v122
    v_rcp_f32 v123, v123
    v_rcp_f32 v124, v124
    v_rcp_f32 v125, v125
    v_rcp_f32 v126, v126
    v_rcp_f32 v127, v127
    v_mul_f32 v80, v80, v120
    v_mul_f32 v81, v81, v121
    v_mul_f32 v82, v82, v122
    v_mul_f32 v83, v83, v123
    v_mul_f32 v84, v84, v124
    v_mul_f32 v85, v85, v125
    v_mul_f32 v86, v86, v126
    v_mul_f32 v87, v87, v127
    v_cvt_pk_bf16_f32 v80, 0, v80
    v_cvt_pk_bf16_f32 v81, 0, v81
    v_cvt_pk_bf16_f32 v82, 0, v82
    v_cvt_pk_bf16_f32 v83, 0, v83
    v_cvt_pk_bf16_f32 v84, 0, v84
    v_cvt_pk_bf16_f32 v85, 0, v85
    v_cvt_pk_bf16_f32 v86, 0, v86
    v_cvt_pk_bf16_f32 v87, 0, v87
    v_mul_f32 v80, v80, v96
    v_mul_f32 v81, v81, v97
    v_mul_f32 v82, v82, v98
    v_mul_f32 v83, v83, v99
    v_mul_f32 v84, v84, v100
    v_mul_f32 v85, v85, v101
    v_mul_f32 v86, v86, v102
    v_mul_f32 v87, v87, v103
    v_mul_f32 v120, 0xbfb8aa3b, v88
    v_mul_f32 v121, 0xbfb8aa3b, v89
    v_mul_f32 v122, 0xbfb8aa3b, v90
    v_mul_f32 v123, 0xbfb8aa3b, v91
    v_mul_f32 v124, 0xbfb8aa3b, v92
    v_mul_f32 v125, 0xbfb8aa3b, v93
    v_mul_f32 v126, 0xbfb8aa3b, v94
    v_mul_f32 v127, 0xbfb8aa3b, v95
    v_exp_f32 v120, v120
    v_exp_f32 v121, v121
    v_exp_f32 v122, v122
    v_exp_f32 v123, v123
    v_exp_f32 v124, v124
    v_exp_f32 v125, v125
    v_exp_f32 v126, v126
    v_exp_f32 v127, v127
    v_add_f32 v120, 1.0, v120
    v_add_f32 v121, 1.0, v121
    v_add_f32 v122, 1.0, v122
    v_add_f32 v123, 1.0, v123
    v_add_f32 v124, 1.0, v124
    v_add_f32 v125, 1.0, v125
    v_add_f32 v126, 1.0, v126
    v_add_f32 v127, 1.0, v127
    v_rcp_f32 v120, v120
    v_rcp_f32 v121, v121
    v_rcp_f32 v122, v122
    v_rcp_f32 v123, v123
    v_rcp_f32 v124, v124
    v_rcp_f32 v125, v125
    v_rcp_f32 v126, v126
    v_rcp_f32 v127, v127
    v_mul_f32 v88, v88, v120
    v_mul_f32 v89, v89, v121
    v_mul_f32 v90, v90, v122
    v_mul_f32 v91, v91, v123
    v_mul_f32 v92, v92, v124
    v_mul_f32 v93, v93, v125
    v_mul_f32 v94, v94, v126
    v_mul_f32 v95, v95, v127
    v_cvt_pk_bf16_f32 v88, 0, v88
    v_cvt_pk_bf16_f32 v89, 0, v89
    v_cvt_pk_bf16_f32 v90, 0, v90
    v_cvt_pk_bf16_f32 v91, 0, v91
    v_cvt_pk_bf16_f32 v92, 0, v92
    v_cvt_pk_bf16_f32 v93, 0, v93
    v_cvt_pk_bf16_f32 v94, 0, v94
    v_cvt_pk_bf16_f32 v95, 0, v95
    v_mul_f32 v88, v88, v104
    v_mul_f32 v89, v89, v105
    v_mul_f32 v90, v90, v106
    v_mul_f32 v91, v91, v107
    v_mul_f32 v92, v92, v108
    v_mul_f32 v93, v93, v109
    v_mul_f32 v94, v94, v110
    v_mul_f32 v95, v95, v111
    v_cvt_pk_bf16_f32 v112, v80, v81
    v_cvt_pk_bf16_f32 v113, v82, v83
    v_cvt_pk_bf16_f32 v114, v84, v85
    v_cvt_pk_bf16_f32 v115, v86, v87
    v_cvt_pk_bf16_f32 v116, v88, v89
    v_cvt_pk_bf16_f32 v117, v90, v91
    v_cvt_pk_bf16_f32 v118, v92, v93
    v_cvt_pk_bf16_f32 v119, v94, v95
    v_lshrrev_b32 v6, 5, v0
    v_lshlrev_b32 v6, 2, v6
    v_bfe_u32 v7, v0, 2, 2
    v_add_u32 v6, v6, v7
    v_mul_u32_u24 v6, 576, v6
    v_bfe_u32 v7, v0, 4, 1
    v_lshl_add_u32 v6, v7, 5, v6
    v_and_b32 v7, 3, v0
    v_lshl_add_u32 v6, v7, 3, v6
    v_add_u32 v6, 132608, v6
    v_lshrrev_b32 v7, 5, v0
    v_lshlrev_b32 v7, 13, v7
    v_and_b32 v8, 31, v0
    v_lshl_add_u32 v7, v8, 2, v7
    v_add_u32 v8, 4096, v7
    s_mov_b32 s46, 10551296

    s_waitcnt vmcnt(0)
    ds_write_b128 v3, v[16:19] offset:0
    ds_write_b128 v3, v[20:23] offset:1152
    ds_write_b128 v3, v[24:27] offset:2304
    ds_write_b128 v3, v[28:31] offset:3456
    ds_write_b128 v3, v[32:35] offset:4608
    ds_write_b128 v3, v[36:39] offset:5760
    ds_write_b128 v3, v[40:43] offset:6912
    ds_write_b128 v3, v[44:47] offset:8064
    ds_write_b128 v3, v[48:51] offset:9216
    ds_write_b128 v3, v[52:55] offset:10368
    ds_write_b128 v3, v[56:59] offset:11520
    ds_write_b128 v3, v[60:63] offset:12672
    ds_write_b128 v3, v[64:67] offset:13824
    ds_write_b128 v3, v[68:71] offset:14976
    ds_write_b128 v3, v[72:75] offset:16128
    ds_write_b128 v3, v[76:79] offset:17280
    v_add_u32 v4, 0, v1
    buffer_load_dwordx4 v[16:19], v4, s[40:43], 0 offen offset:512
    v_add_u32 v4, 2048, v1
    buffer_load_dwordx4 v[20:23], v4, s[40:43], 0 offen offset:512
    v_add_u32 v4, 4096, v1
    buffer_load_dwordx4 v[24:27], v4, s[40:43], 0 offen offset:512
    v_add_u32 v4, 6144, v1
    buffer_load_dwordx4 v[28:31], v4, s[40:43], 0 offen offset:512
    v_add_u32 v4, 8192, v1
    buffer_load_dwordx4 v[32:35], v4, s[40:43], 0 offen offset:512
    v_add_u32 v4, 10240, v1
    buffer_load_dwordx4 v[36:39], v4, s[40:43], 0 offen offset:512
    v_add_u32 v4, 12288, v1
    buffer_load_dwordx4 v[40:43], v4, s[40:43], 0 offen offset:512
    v_add_u32 v4, 14336, v1
    buffer_load_dwordx4 v[44:47], v4, s[40:43], 0 offen offset:512
    v_add_u32 v4, 16384, v1
    buffer_load_dwordx4 v[48:51], v4, s[40:43], 0 offen offset:512
    v_add_u32 v4, 18432, v1
    buffer_load_dwordx4 v[52:55], v4, s[40:43], 0 offen offset:512
    v_add_u32 v4, 20480, v1
    buffer_load_dwordx4 v[56:59], v4, s[40:43], 0 offen offset:512
    v_add_u32 v4, 22528, v1
    buffer_load_dwordx4 v[60:63], v4, s[40:43], 0 offen offset:512
    v_add_u32 v4, 24576, v1
    buffer_load_dwordx4 v[64:67], v4, s[40:43], 0 offen offset:512
    v_add_u32 v4, 26624, v1
    buffer_load_dwordx4 v[68:71], v4, s[40:43], 0 offen offset:512
    v_add_u32 v4, 28672, v1
    buffer_load_dwordx4 v[72:75], v4, s[40:43], 0 offen offset:512
    v_add_u32 v4, 30720, v1
    buffer_load_dwordx4 v[76:79], v4, s[40:43], 0 offen offset:512
    s_waitcnt lgkmcnt(0)
    ds_read_b64_tr_b16 v[80:81], v6 offset:0
    ds_read_b64_tr_b16 v[82:83], v6 offset:4608
    ds_read_b64_tr_b16 v[84:85], v6 offset:9216
    ds_read_b64_tr_b16 v[86:87], v6 offset:13824
    v_mov_b32 v96, 0
    v_mov_b32 v97, 0
    v_mov_b32 v98, 0
    v_mov_b32 v99, 0
    v_mov_b32 v100, 0
    v_mov_b32 v101, 0
    v_mov_b32 v102, 0
    v_mov_b32 v103, 0
    v_mov_b32 v104, 0
    v_mov_b32 v105, 0
    v_mov_b32 v106, 0
    v_mov_b32 v107, 0
    v_mov_b32 v108, 0
    v_mov_b32 v109, 0
    v_mov_b32 v110, 0
    v_mov_b32 v111, 0
    s_waitcnt lgkmcnt(0)
    v_mfma_f32_32x32x16_bf16 v[96:111], v[112:115], v[80:83], v[96:111]
    v_mfma_f32_32x32x16_bf16 v[96:111], v[116:119], v[84:87], v[96:111]
    s_nop 15
    s_nop 3
    buffer_atomic_add_f32 v96, v7, s[8:11], s46 offen offset:0
    buffer_atomic_add_f32 v97, v7, s[8:11], s46 offen offset:2048
    buffer_atomic_add_f32 v98, v8, s[8:11], s46 offen offset:0
    buffer_atomic_add_f32 v99, v8, s[8:11], s46 offen offset:2048
    s_nop 1
    ds_read_b64_tr_b16 v[88:89], v6 offset:64
    ds_read_b64_tr_b16 v[90:91], v6 offset:4672
    ds_read_b64_tr_b16 v[92:93], v6 offset:9280
    ds_read_b64_tr_b16 v[94:95], v6 offset:13888
    v_mov_b32 v96, 0
    v_mov_b32 v97, 0
    v_mov_b32 v98, 0
    v_mov_b32 v99, 0
    s_waitcnt lgkmcnt(0)
    v_mfma_f32_32x32x16_bf16 v[96:111], v[112:115], v[88:91], v[96:111]
    v_mfma_f32_32x32x16_bf16 v[96:111], v[116:119], v[92:95], v[96:111]
    s_nop 15
    s_nop 3
    buffer_atomic_add_f32 v96, v7, s[8:11], s46 offen offset:128
    buffer_atomic_add_f32 v97, v7, s[8:11], s46 offen offset:2176
    buffer_atomic_add_f32 v98, v8, s[8:11], s46 offen offset:128
    buffer_atomic_add_f32 v99, v8, s[8:11], s46 offen offset:2176
    s_nop 1
    ds_read_b64_tr_b16 v[80:81], v6 offset:128
    ds_read_b64_tr_b16 v[82:83], v6 offset:4736
    ds_read_b64_tr_b16 v[84:85], v6 offset:9344
    ds_read_b64_tr_b16 v[86:87], v6 offset:13952
    v_mov_b32 v96, 0
    v_mov_b32 v97, 0
    v_mov_b32 v98, 0
    v_mov_b32 v99, 0
    s_waitcnt lgkmcnt(0)
    v_mfma_f32_32x32x16_bf16 v[96:111], v[112:115], v[80:83], v[96:111]
    v_mfma_f32_32x32x16_bf16 v[96:111], v[116:119], v[84:87], v[96:111]
    s_nop 15
    s_nop 3
    buffer_atomic_add_f32 v96, v7, s[8:11], s46 offen offset:256
    buffer_atomic_add_f32 v97, v7, s[8:11], s46 offen offset:2304
    buffer_atomic_add_f32 v98, v8, s[8:11], s46 offen offset:256
    buffer_atomic_add_f32 v99, v8, s[8:11], s46 offen offset:2304
    s_nop 1
    ds_read_b64_tr_b16 v[88:89], v6 offset:192
    ds_read_b64_tr_b16 v[90:91], v6 offset:4800
    ds_read_b64_tr_b16 v[92:93], v6 offset:9408
    ds_read_b64_tr_b16 v[94:95], v6 offset:14016
    v_mov_b32 v96, 0
    v_mov_b32 v97, 0
    v_mov_b32 v98, 0
    v_mov_b32 v99, 0
    s_waitcnt lgkmcnt(0)
    v_mfma_f32_32x32x16_bf16 v[96:111], v[112:115], v[88:91], v[96:111]
    v_mfma_f32_32x32x16_bf16 v[96:111], v[116:119], v[92:95], v[96:111]
    s_nop 15
    s_nop 3
    buffer_atomic_add_f32 v96, v7, s[8:11], s46 offen offset:384
    buffer_atomic_add_f32 v97, v7, s[8:11], s46 offen offset:2432
    buffer_atomic_add_f32 v98, v8, s[8:11], s46 offen offset:384
    buffer_atomic_add_f32 v99, v8, s[8:11], s46 offen offset:2432
    s_nop 1
    ds_read_b64_tr_b16 v[80:81], v6 offset:256
    ds_read_b64_tr_b16 v[82:83], v6 offset:4864
    ds_read_b64_tr_b16 v[84:85], v6 offset:9472
    ds_read_b64_tr_b16 v[86:87], v6 offset:14080
    v_mov_b32 v96, 0
    v_mov_b32 v97, 0
    v_mov_b32 v98, 0
    v_mov_b32 v99, 0
    s_waitcnt lgkmcnt(0)
    v_mfma_f32_32x32x16_bf16 v[96:111], v[112:115], v[80:83], v[96:111]
    v_mfma_f32_32x32x16_bf16 v[96:111], v[116:119], v[84:87], v[96:111]
    s_nop 15
    s_nop 3
    buffer_atomic_add_f32 v96, v7, s[8:11], s46 offen offset:512
    buffer_atomic_add_f32 v97, v7, s[8:11], s46 offen offset:2560
    buffer_atomic_add_f32 v98, v8, s[8:11], s46 offen offset:512
    buffer_atomic_add_f32 v99, v8, s[8:11], s46 offen offset:2560
    s_nop 1
    ds_read_b64_tr_b16 v[88:89], v6 offset:320
    ds_read_b64_tr_b16 v[90:91], v6 offset:4928
    ds_read_b64_tr_b16 v[92:93], v6 offset:9536
    ds_read_b64_tr_b16 v[94:95], v6 offset:14144
    v_mov_b32 v96, 0
    v_mov_b32 v97, 0
    v_mov_b32 v98, 0
    v_mov_b32 v99, 0
    s_waitcnt lgkmcnt(0)
    v_mfma_f32_32x32x16_bf16 v[96:111], v[112:115], v[88:91], v[96:111]
    v_mfma_f32_32x32x16_bf16 v[96:111], v[116:119], v[92:95], v[96:111]
    s_nop 15
    s_nop 3
    buffer_atomic_add_f32 v96, v7, s[8:11], s46 offen offset:640
    buffer_atomic_add_f32 v97, v7, s[8:11], s46 offen offset:2688
    buffer_atomic_add_f32 v98, v8, s[8:11], s46 offen offset:640
    buffer_atomic_add_f32 v99, v8, s[8:11], s46 offen offset:2688
    s_nop 1
    ds_read_b64_tr_b16 v[80:81], v6 offset:384
    ds_read_b64_tr_b16 v[82:83], v6 offset:4992
    ds_read_b64_tr_b16 v[84:85], v6 offset:9600
    ds_read_b64_tr_b16 v[86:87], v6 offset:14208
    v_mov_b32 v96, 0
    v_mov_b32 v97, 0
    v_mov_b32 v98, 0
    v_mov_b32 v99, 0
    s_waitcnt lgkmcnt(0)
    v_mfma_f32_32x32x16_bf16 v[96:111], v[112:115], v[80:83], v[96:111]
    v_mfma_f32_32x32x16_bf16 v[96:111], v[116:119], v[84:87], v[96:111]
    s_nop 15
    s_nop 3
    buffer_atomic_add_f32 v96, v7, s[8:11], s46 offen offset:768
    buffer_atomic_add_f32 v97, v7, s[8:11], s46 offen offset:2816
    buffer_atomic_add_f32 v98, v8, s[8:11], s46 offen offset:768
    buffer_atomic_add_f32 v99, v8, s[8:11], s46 offen offset:2816
    s_nop 1
    ds_read_b64_tr_b16 v[88:89], v6 offset:448
    ds_read_b64_tr_b16 v[90:91], v6 offset:5056
    ds_read_b64_tr_b16 v[92:93], v6 offset:9664
    ds_read_b64_tr_b16 v[94:95], v6 offset:14272
    v_mov_b32 v96, 0
    v_mov_b32 v97, 0
    v_mov_b32 v98, 0
    v_mov_b32 v99, 0
    s_waitcnt lgkmcnt(0)
    v_mfma_f32_32x32x16_bf16 v[96:111], v[112:115], v[88:91], v[96:111]
    v_mfma_f32_32x32x16_bf16 v[96:111], v[116:119], v[92:95], v[96:111]
    s_nop 15
    s_nop 3
    buffer_atomic_add_f32 v96, v7, s[8:11], s46 offen offset:896
    buffer_atomic_add_f32 v97, v7, s[8:11], s46 offen offset:2944
    buffer_atomic_add_f32 v98, v8, s[8:11], s46 offen offset:896
    buffer_atomic_add_f32 v99, v8, s[8:11], s46 offen offset:2944
    s_nop 1
    s_waitcnt vmcnt(0)
    ds_write_b128 v3, v[16:19] offset:0
    ds_write_b128 v3, v[20:23] offset:1152
    ds_write_b128 v3, v[24:27] offset:2304
    ds_write_b128 v3, v[28:31] offset:3456
    ds_write_b128 v3, v[32:35] offset:4608
    ds_write_b128 v3, v[36:39] offset:5760
    ds_write_b128 v3, v[40:43] offset:6912
    ds_write_b128 v3, v[44:47] offset:8064
    ds_write_b128 v3, v[48:51] offset:9216
    ds_write_b128 v3, v[52:55] offset:10368
    ds_write_b128 v3, v[56:59] offset:11520
    ds_write_b128 v3, v[60:63] offset:12672
    ds_write_b128 v3, v[64:67] offset:13824
    ds_write_b128 v3, v[68:71] offset:14976
    ds_write_b128 v3, v[72:75] offset:16128
    ds_write_b128 v3, v[76:79] offset:17280
    s_waitcnt lgkmcnt(0)
    ds_read_b64_tr_b16 v[80:81], v6 offset:0
    ds_read_b64_tr_b16 v[82:83], v6 offset:4608
    ds_read_b64_tr_b16 v[84:85], v6 offset:9216
    ds_read_b64_tr_b16 v[86:87], v6 offset:13824
    v_mov_b32 v96, 0
    v_mov_b32 v97, 0
    v_mov_b32 v98, 0
    v_mov_b32 v99, 0
    s_waitcnt lgkmcnt(0)
    v_mfma_f32_32x32x16_bf16 v[96:111], v[112:115], v[80:83], v[96:111]
    v_mfma_f32_32x32x16_bf16 v[96:111], v[116:119], v[84:87], v[96:111]
    s_nop 15
    s_nop 3
    buffer_atomic_add_f32 v96, v7, s[8:11], s46 offen offset:1024
    buffer_atomic_add_f32 v97, v7, s[8:11], s46 offen offset:3072
    buffer_atomic_add_f32 v98, v8, s[8:11], s46 offen offset:1024
    buffer_atomic_add_f32 v99, v8, s[8:11], s46 offen offset:3072
    s_nop 1
    ds_read_b64_tr_b16 v[88:89], v6 offset:64
    ds_read_b64_tr_b16 v[90:91], v6 offset:4672
    ds_read_b64_tr_b16 v[92:93], v6 offset:9280
    ds_read_b64_tr_b16 v[94:95], v6 offset:13888
    v_mov_b32 v96, 0
    v_mov_b32 v97, 0
    v_mov_b32 v98, 0
    v_mov_b32 v99, 0
    s_waitcnt lgkmcnt(0)
    v_mfma_f32_32x32x16_bf16 v[96:111], v[112:115], v[88:91], v[96:111]
    v_mfma_f32_32x32x16_bf16 v[96:111], v[116:119], v[92:95], v[96:111]
    s_nop 15
    s_nop 3
    buffer_atomic_add_f32 v96, v7, s[8:11], s46 offen offset:1152
    buffer_atomic_add_f32 v97, v7, s[8:11], s46 offen offset:3200
    buffer_atomic_add_f32 v98, v8, s[8:11], s46 offen offset:1152
    buffer_atomic_add_f32 v99, v8, s[8:11], s46 offen offset:3200
    s_nop 1
    ds_read_b64_tr_b16 v[80:81], v6 offset:128
    ds_read_b64_tr_b16 v[82:83], v6 offset:4736
    ds_read_b64_tr_b16 v[84:85], v6 offset:9344
    ds_read_b64_tr_b16 v[86:87], v6 offset:13952
    v_mov_b32 v96, 0
    v_mov_b32 v97, 0
    v_mov_b32 v98, 0
    v_mov_b32 v99, 0
    s_waitcnt lgkmcnt(0)
    v_mfma_f32_32x32x16_bf16 v[96:111], v[112:115], v[80:83], v[96:111]
    v_mfma_f32_32x32x16_bf16 v[96:111], v[116:119], v[84:87], v[96:111]
    s_nop 15
    s_nop 3
    buffer_atomic_add_f32 v96, v7, s[8:11], s46 offen offset:1280
    buffer_atomic_add_f32 v97, v7, s[8:11], s46 offen offset:3328
    buffer_atomic_add_f32 v98, v8, s[8:11], s46 offen offset:1280
    buffer_atomic_add_f32 v99, v8, s[8:11], s46 offen offset:3328
    s_nop 1
    ds_read_b64_tr_b16 v[88:89], v6 offset:192
    ds_read_b64_tr_b16 v[90:91], v6 offset:4800
    ds_read_b64_tr_b16 v[92:93], v6 offset:9408
    ds_read_b64_tr_b16 v[94:95], v6 offset:14016
    v_mov_b32 v96, 0
    v_mov_b32 v97, 0
    v_mov_b32 v98, 0
    v_mov_b32 v99, 0
    s_waitcnt lgkmcnt(0)
    v_mfma_f32_32x32x16_bf16 v[96:111], v[112:115], v[88:91], v[96:111]
    v_mfma_f32_32x32x16_bf16 v[96:111], v[116:119], v[92:95], v[96:111]
    s_nop 15
    s_nop 3
    buffer_atomic_add_f32 v96, v7, s[8:11], s46 offen offset:1408
    buffer_atomic_add_f32 v97, v7, s[8:11], s46 offen offset:3456
    buffer_atomic_add_f32 v98, v8, s[8:11], s46 offen offset:1408
    buffer_atomic_add_f32 v99, v8, s[8:11], s46 offen offset:3456
    s_nop 1
    ds_read_b64_tr_b16 v[80:81], v6 offset:256
    ds_read_b64_tr_b16 v[82:83], v6 offset:4864
    ds_read_b64_tr_b16 v[84:85], v6 offset:9472
    ds_read_b64_tr_b16 v[86:87], v6 offset:14080
    v_mov_b32 v96, 0
    v_mov_b32 v97, 0
    v_mov_b32 v98, 0
    v_mov_b32 v99, 0
    s_waitcnt lgkmcnt(0)
    v_mfma_f32_32x32x16_bf16 v[96:111], v[112:115], v[80:83], v[96:111]
    v_mfma_f32_32x32x16_bf16 v[96:111], v[116:119], v[84:87], v[96:111]
    s_nop 15
    s_nop 3
    buffer_atomic_add_f32 v96, v7, s[8:11], s46 offen offset:1536
    buffer_atomic_add_f32 v97, v7, s[8:11], s46 offen offset:3584
    buffer_atomic_add_f32 v98, v8, s[8:11], s46 offen offset:1536
    buffer_atomic_add_f32 v99, v8, s[8:11], s46 offen offset:3584
    s_nop 1
    ds_read_b64_tr_b16 v[88:89], v6 offset:320
    ds_read_b64_tr_b16 v[90:91], v6 offset:4928
    ds_read_b64_tr_b16 v[92:93], v6 offset:9536
    ds_read_b64_tr_b16 v[94:95], v6 offset:14144
    v_mov_b32 v96, 0
    v_mov_b32 v97, 0
    v_mov_b32 v98, 0
    v_mov_b32 v99, 0
    s_waitcnt lgkmcnt(0)
    v_mfma_f32_32x32x16_bf16 v[96:111], v[112:115], v[88:91], v[96:111]
    v_mfma_f32_32x32x16_bf16 v[96:111], v[116:119], v[92:95], v[96:111]
    s_nop 15
    s_nop 3
    buffer_atomic_add_f32 v96, v7, s[8:11], s46 offen offset:1664
    buffer_atomic_add_f32 v97, v7, s[8:11], s46 offen offset:3712
    buffer_atomic_add_f32 v98, v8, s[8:11], s46 offen offset:1664
    buffer_atomic_add_f32 v99, v8, s[8:11], s46 offen offset:3712
    s_nop 1
    ds_read_b64_tr_b16 v[80:81], v6 offset:384
    ds_read_b64_tr_b16 v[82:83], v6 offset:4992
    ds_read_b64_tr_b16 v[84:85], v6 offset:9600
    ds_read_b64_tr_b16 v[86:87], v6 offset:14208
    v_mov_b32 v96, 0
    v_mov_b32 v97, 0
    v_mov_b32 v98, 0
    v_mov_b32 v99, 0
    s_waitcnt lgkmcnt(0)
    v_mfma_f32_32x32x16_bf16 v[96:111], v[112:115], v[80:83], v[96:111]
    v_mfma_f32_32x32x16_bf16 v[96:111], v[116:119], v[84:87], v[96:111]
    s_nop 15
    s_nop 3
    buffer_atomic_add_f32 v96, v7, s[8:11], s46 offen offset:1792
    buffer_atomic_add_f32 v97, v7, s[8:11], s46 offen offset:3840
    buffer_atomic_add_f32 v98, v8, s[8:11], s46 offen offset:1792
    buffer_atomic_add_f32 v99, v8, s[8:11], s46 offen offset:3840
    s_nop 1
    ds_read_b64_tr_b16 v[88:89], v6 offset:448
    ds_read_b64_tr_b16 v[90:91], v6 offset:5056
    ds_read_b64_tr_b16 v[92:93], v6 offset:9664
    ds_read_b64_tr_b16 v[94:95], v6 offset:14272
    v_mov_b32 v96, 0
    v_mov_b32 v97, 0
    v_mov_b32 v98, 0
    v_mov_b32 v99, 0
    s_waitcnt lgkmcnt(0)
    v_mfma_f32_32x32x16_bf16 v[96:111], v[112:115], v[88:91], v[96:111]
    v_mfma_f32_32x32x16_bf16 v[96:111], v[116:119], v[92:95], v[96:111]
    s_nop 15
    s_nop 3
    buffer_atomic_add_f32 v96, v7, s[8:11], s46 offen offset:1920
    buffer_atomic_add_f32 v97, v7, s[8:11], s46 offen offset:3968
    buffer_atomic_add_f32 v98, v8, s[8:11], s46 offen offset:1920
    buffer_atomic_add_f32 v99, v8, s[8:11], s46 offen offset:3968
    s_nop 1
    s_waitcnt vmcnt(0)
k2_end:
    s_endpgm
k2_attn:
    v_and_b32 v44, 31, v0
    s_lshl_b32 s15, s14, 8
    s_lshl_b32 s18, s12, 5
    s_add_u32 s15, s15, s18
    v_add_u32 v44, s15, v44
    v_lshlrev_b32 v47, 10, v44
    v_lshlrev_b32 v44, 5, v44
    v_lshrrev_b32 v45, 5, v0
    v_lshl_add_u32 v44, v45, 4, v44
    v_lshl_add_u32 v47, v45, 4, v47
    s_lshl_b32 s15, s13, 16
    s_add_u32 s18, s15, 2097152
    buffer_load_dwordx4 v[4:7], v44, s[8:11], s18 offen
    s_add_u32 s16, s15, 4194304
    s_add_u32 s17, s15, 6291456
    s_lshl_b32 s18, s12, 10
    s_add_u32 s16, s16, s18
    s_add_u32 s17, s17, s18
    v_lshlrev_b32 v46, 4, v0

    s_add_u32 s19, s18, 0
    s_mov_b32 m0, s19
    s_add_u32 s19, s16, 0
    buffer_load_dwordx4 v46, s[8:11], s19 offen lds
    s_add_u32 s19, s18, 65536
    s_mov_b32 m0, s19
    s_add_u32 s19, s17, 0
    buffer_load_dwordx4 v46, s[8:11], s19 offen lds
    s_add_u32 s19, s18, 8192
    s_mov_b32 m0, s19
    s_add_u32 s19, s16, 8192
    buffer_load_dwordx4 v46, s[8:11], s19 offen lds
    s_add_u32 s19, s18, 73728
    s_mov_b32 m0, s19
    s_add_u32 s19, s17, 8192
    buffer_load_dwordx4 v46, s[8:11], s19 offen lds
    s_add_u32 s19, s18, 16384
    s_mov_b32 m0, s19
    s_add_u32 s19, s16, 16384
    buffer_load_dwordx4 v46, s[8:11], s19 offen lds
    s_add_u32 s19, s18, 81920
    s_mov_b32 m0, s19
    s_add_u32 s19, s17, 16384
    buffer_load_dwordx4 v46, s[8:11], s19 offen lds
    s_add_u32 s19, s18, 24576
    s_mov_b32 m0, s19
    s_add_u32 s19, s16, 24576
    buffer_load_dwordx4 v46, s[8:11], s19 offen lds
    s_add_u32 s19, s18, 90112
    s_mov_b32 m0, s19
    s_add_u32 s19, s17, 24576
    buffer_load_dwordx4 v46, s[8:11], s19 offen lds
    s_add_u32 s19, s18, 32768
    s_mov_b32 m0, s19
    s_add_u32 s19, s16, 32768
    buffer_load_dwordx4 v46, s[8:11], s19 offen lds
    s_add_u32 s19, s18, 98304
    s_mov_b32 m0, s19
    s_add_u32 s19, s17, 32768
    buffer_load_dwordx4 v46, s[8:11], s19 offen lds
    s_add_u32 s19, s18, 40960
    s_mov_b32 m0, s19
    s_add_u32 s19, s16, 40960
    buffer_load_dwordx4 v46, s[8:11], s19 offen lds
    s_add_u32 s19, s18, 106496
    s_mov_b32 m0, s19
    s_add_u32 s19, s17, 40960
    buffer_load_dwordx4 v46, s[8:11], s19 offen lds
    s_add_u32 s19, s18, 49152
    s_mov_b32 m0, s19
    s_add_u32 s19, s16, 49152
    buffer_load_dwordx4 v46, s[8:11], s19 offen lds
    s_add_u32 s19, s18, 114688
    s_mov_b32 m0, s19
    s_add_u32 s19, s17, 49152
    buffer_load_dwordx4 v46, s[8:11], s19 offen lds
    s_add_u32 s19, s18, 57344
    s_mov_b32 m0, s19
    s_add_u32 s19, s16, 57344
    buffer_load_dwordx4 v46, s[8:11], s19 offen lds
    s_add_u32 s19, s18, 122880
    s_mov_b32 m0, s19
    s_add_u32 s19, s17, 57344
    buffer_load_dwordx4 v46, s[8:11], s19 offen lds
    v_mov_b32 v80, 0
    v_mov_b32 v96, 0
    v_mov_b32 v81, 0
    v_mov_b32 v97, 0
    v_mov_b32 v82, 0
    v_mov_b32 v98, 0
    v_mov_b32 v83, 0
    v_mov_b32 v99, 0
    v_mov_b32 v84, 0
    v_mov_b32 v100, 0
    v_mov_b32 v85, 0
    v_mov_b32 v101, 0
    v_mov_b32 v86, 0
    v_mov_b32 v102, 0
    v_mov_b32 v87, 0
    v_mov_b32 v103, 0
    v_mov_b32 v88, 0
    v_mov_b32 v104, 0
    v_mov_b32 v89, 0
    v_mov_b32 v105, 0
    v_mov_b32 v90, 0
    v_mov_b32 v106, 0
    v_mov_b32 v91, 0
    v_mov_b32 v107, 0
    v_mov_b32 v92, 0
    v_mov_b32 v108, 0
    v_mov_b32 v93, 0
    v_mov_b32 v109, 0
    v_mov_b32 v94, 0
    v_mov_b32 v110, 0
    v_mov_b32 v95, 0
    v_mov_b32 v111, 0
    v_mov_b32 v120, 0
    v_mov_b32 v112, 0
    v_mov_b32 v121, 0
    v_mov_b32 v113, 0
    v_mov_b32 v122, 0
    v_mov_b32 v114, 0
    v_mov_b32 v123, 0
    v_mov_b32 v115, 0
    v_mov_b32 v124, 0
    v_mov_b32 v116, 0
    v_mov_b32 v125, 0
    v_mov_b32 v117, 0
    v_mov_b32 v126, 0
    v_mov_b32 v118, 0
    v_mov_b32 v127, 0
    v_mov_b32 v119, 0
    v_and_b32 v44, 31, v0
    v_lshlrev_b32 v40, 5, v44
    v_lshrrev_b32 v45, 5, v0
    v_lshl_add_u32 v40, v45, 4, v40
    v_lshlrev_b32 v41, 8, v45
    v_and_b32 v45, 15, v0
    v_lshl_add_u32 v41, v45, 4, v41
    v_add_u32 v41, 65536, v41
    v_cmp_gt_u32 vcc, 16, v44
    v_mov_b32 v3, 0
    v_mov_b32 v45, 1024
    v_cndmask_b32 v3, v3, v45, vcc
    v_cmp_eq_u32 s[20:21], 16, v44
    v_mov_b32 v45, 131344
    v_mov_b32 v46, 131328
    s_nop 0
    v_cndmask_b32 v45, v45, v46, s[20:21]
    v_cndmask_b32 v41, v45, v41, vcc
    v_mov_b32 v42, 131072
    v_mov_b32 v43, 1
    s_mov_b32 s22, 0

    s_barrier
    s_waitcnt vmcnt(14)
    ds_add_u32 v42, v43
k2_polla_10:
    ds_read_b32 v44, v42
    s_waitcnt lgkmcnt(0)
    v_readfirstlane_b32 s23, v44
    s_cmp_lt_u32 s23, 512
    s_cbranch_scc1 k2_polla_10

    ds_read_b128 v[8:11], v40
    ds_read_b128 v[12:15], v40 offset:1024
    s_waitcnt vmcnt(14) lgkmcnt(1)
    v_mfma_f32_32x32x16_bf16 v[48:63], v[8:11], v[4:7], v[80:95]
    s_nop 15
    s_nop 3

    v_max3_f32 v44, v48, v49, v50
    v_max3_f32 v44, v44, v51, v52
    v_max3_f32 v44, v44, v53, v54
    v_max3_f32 v44, v44, v55, v56
    v_max3_f32 v44, v44, v57, v58
    v_max3_f32 v44, v44, v59, v60
    v_max3_f32 v44, v44, v61, v62
    v_max_f32 v44, v44, v63
    v_mov_b32 v45, v44
    s_nop 1
    v_permlane32_swap_b32 v44, v45
    s_nop 1
    v_max_f32 v44, v44, v45
    v_add_f32 v44, 0x42c00000, v44
    v_sub_f32 v48, v48, v44
    v_sub_f32 v80, 0, v44
    v_sub_f32 v49, v49, v44
    v_sub_f32 v81, 0, v44
    v_sub_f32 v50, v50, v44
    v_sub_f32 v82, 0, v44
    v_sub_f32 v51, v51, v44
    v_sub_f32 v83, 0, v44
    v_sub_f32 v52, v52, v44
    v_sub_f32 v84, 0, v44
    v_sub_f32 v53, v53, v44
    v_sub_f32 v85, 0, v44
    v_sub_f32 v54, v54, v44
    v_sub_f32 v86, 0, v44
    v_sub_f32 v55, v55, v44
    v_sub_f32 v87, 0, v44
    v_sub_f32 v56, v56, v44
    v_sub_f32 v88, 0, v44
    v_sub_f32 v57, v57, v44
    v_sub_f32 v89, 0, v44
    v_sub_f32 v58, v58, v44
    v_sub_f32 v90, 0, v44
    v_sub_f32 v59, v59, v44
    v_sub_f32 v91, 0, v44
    v_sub_f32 v60, v60, v44
    v_sub_f32 v92, 0, v44
    v_sub_f32 v61, v61, v44
    v_sub_f32 v93, 0, v44
    v_sub_f32 v62, v62, v44
    v_sub_f32 v94, 0, v44
    v_sub_f32 v63, v63, v44
    v_sub_f32 v95, 0, v44
    s_mov_b64 vcc, 0
k2_loop:
    s_cmp_lg_u32 s22, 0
    s_cbranch_scc1 k2_w_11
    s_waitcnt vmcnt(12)
    ds_add_u32 v42, v43 offset:4
    s_branch k2_wd_19
k2_w_11:
    s_cmp_lg_u32 s22, 1
    s_cbranch_scc1 k2_w_12
    s_waitcnt vmcnt(10)
    ds_add_u32 v42, v43 offset:8
    s_branch k2_wd_19
k2_w_12:
    s_cmp_lg_u32 s22, 2
    s_cbranch_scc1 k2_w_13
    s_waitcnt vmcnt(8)
    ds_add_u32 v42, v43 offset:12
    s_branch k2_wd_19
k2_w_13:
    s_cmp_lg_u32 s22, 3
    s_cbranch_scc1 k2_w_14
    s_waitcnt vmcnt(6)
    ds_add_u32 v42, v43 offset:16
    s_branch k2_wd_19
k2_w_14:
    s_cmp_lg_u32 s22, 4
    s_cbranch_scc1 k2_w_15
    s_waitcnt vmcnt(4)
    ds_add_u32 v42, v43 offset:20
    s_branch k2_wd_19
k2_w_15:
    s_cmp_lg_u32 s22, 5
    s_cbranch_scc1 k2_w_16
    s_waitcnt vmcnt(2)
    ds_add_u32 v42, v43 offset:24
    s_branch k2_wd_19
k2_w_16:
    s_cmp_lg_u32 s22, 6
    s_cbranch_scc1 k2_w_17
    s_waitcnt vmcnt(0)
    ds_add_u32 v42, v43 offset:28
    s_branch k2_wd_19
k2_w_17:
k2_wd_19:
k2_head0:
    ds_read_b128 v[16:19], v41
    ds_read_b128 v[20:23], v41 offset:512
    v_add_u32 v41, v41, v3
    v_exp_f32 v32, v48
    v_exp_f32 v33, v49
    s_cbranch_vccnz k2_slow7
    s_waitcnt lgkmcnt(2)
    v_mfma_f32_32x32x16_bf16 v[64:79], v[12:15], v[4:7], v[80:95]
    ds_read_b128 v[8:11], v40 offset:2048
    v_exp_f32 v34, v50
    v_exp_f32 v35, v51
    v_cvt_pk_bf16_f32 v24, v32, v33
    v_exp_f32 v36, v52
    v_exp_f32 v37, v53
    v_cvt_pk_bf16_f32 v25, v34, v35
    v_mfma_f32_32x32x16_bf16 v[96:111], v[120:123], v[112:115], v[96:111]
    v_exp_f32 v38, v54
    v_exp_f32 v39, v55
    v_cvt_pk_bf16_f32 v26, v36, v37
    v_exp_f32 v32, v56
    v_exp_f32 v33, v57
    v_cvt_pk_bf16_f32 v27, v38, v39
    v_exp_f32 v34, v58
    v_exp_f32 v35, v59
    v_cvt_pk_bf16_f32 v28, v32, v33
    v_mfma_f32_32x32x16_bf16 v[96:111], v[124:127], v[116:119], v[96:111]
    v_exp_f32 v36, v60
    v_exp_f32 v37, v61
    v_cvt_pk_bf16_f32 v29, v34, v35
    v_exp_f32 v38, v62
    v_exp_f32 v39, v63
    v_cvt_pk_bf16_f32 v30, v36, v37
    v_or3_b32 v44, v24, v25, v26
    v_or3_b32 v44, v44, v27, v28
    v_cvt_pk_bf16_f32 v31, v38, v39
    v_or3_b32 v44, v44, v29, v30
    v_or_b32 v44, v44, v31
    v_and_b32 v44, 0x40004000, v44
    v_cmp_ne_u32 vcc, 0, v44

k2_head1:
    ds_read_b128 v[120:123], v41
    ds_read_b128 v[124:127], v41 offset:512
    v_add_u32 v41, v41, v3
    v_exp_f32 v32, v64
    v_exp_f32 v33, v65
    s_cbranch_vccnz k2_slow0
    s_waitcnt lgkmcnt(2)
    v_mfma_f32_32x32x16_bf16 v[48:63], v[8:11], v[4:7], v[80:95]
    ds_read_b128 v[12:15], v40 offset:3072
    v_exp_f32 v34, v66
    v_exp_f32 v35, v67
    v_cvt_pk_bf16_f32 v112, v32, v33
    v_exp_f32 v36, v68
    v_exp_f32 v37, v69
    v_cvt_pk_bf16_f32 v113, v34, v35
    v_mfma_f32_32x32x16_bf16 v[96:111], v[16:19], v[24:27], v[96:111]
    v_exp_f32 v38, v70
    v_exp_f32 v39, v71
    v_cvt_pk_bf16_f32 v114, v36, v37
    v_exp_f32 v32, v72
    v_exp_f32 v33, v73
    v_cvt_pk_bf16_f32 v115, v38, v39
    v_exp_f32 v34, v74
    v_exp_f32 v35, v75
    v_cvt_pk_bf16_f32 v116, v32, v33
    v_mfma_f32_32x32x16_bf16 v[96:111], v[20:23], v[28:31], v[96:111]
    v_exp_f32 v36, v76
    v_exp_f32 v37, v77
    v_cvt_pk_bf16_f32 v117, v34, v35
    v_exp_f32 v38, v78
    v_exp_f32 v39, v79
    v_cvt_pk_bf16_f32 v118, v36, v37
    v_or3_b32 v44, v112, v113, v114
    v_or3_b32 v44, v44, v115, v116
    v_cvt_pk_bf16_f32 v119, v38, v39
    v_or3_b32 v44, v44, v117, v118
    v_or_b32 v44, v44, v119
    v_and_b32 v44, 0x40004000, v44
    v_cmp_ne_u32 vcc, 0, v44

k2_head2:
    ds_read_b128 v[16:19], v41
    ds_read_b128 v[20:23], v41 offset:512
    v_add_u32 v41, v41, v3
    v_exp_f32 v32, v48
    v_exp_f32 v33, v49
    s_cbranch_vccnz k2_slow1
    s_waitcnt lgkmcnt(2)
    v_mfma_f32_32x32x16_bf16 v[64:79], v[12:15], v[4:7], v[80:95]
    ds_read_b128 v[8:11], v40 offset:4096
    v_exp_f32 v34, v50
    v_exp_f32 v35, v51
    v_cvt_pk_bf16_f32 v24, v32, v33
    v_exp_f32 v36, v52
    v_exp_f32 v37, v53
    v_cvt_pk_bf16_f32 v25, v34, v35
    v_mfma_f32_32x32x16_bf16 v[96:111], v[120:123], v[112:115], v[96:111]
    v_exp_f32 v38, v54
    v_exp_f32 v39, v55
    v_cvt_pk_bf16_f32 v26, v36, v37
    v_exp_f32 v32, v56
    v_exp_f32 v33, v57
    v_cvt_pk_bf16_f32 v27, v38, v39
    v_exp_f32 v34, v58
    v_exp_f32 v35, v59
    v_cvt_pk_bf16_f32 v28, v32, v33
    v_mfma_f32_32x32x16_bf16 v[96:111], v[124:127], v[116:119], v[96:111]
    v_exp_f32 v36, v60
    v_exp_f32 v37, v61
    v_cvt_pk_bf16_f32 v29, v34, v35
    v_exp_f32 v38, v62
    v_exp_f32 v39, v63
    v_cvt_pk_bf16_f32 v30, v36, v37
    v_or3_b32 v44, v24, v25, v26
    v_or3_b32 v44, v44, v27, v28
    v_cvt_pk_bf16_f32 v31, v38, v39
    v_or3_b32 v44, v44, v29, v30
    v_or_b32 v44, v44, v31
    v_and_b32 v44, 0x40004000, v44
    v_cmp_ne_u32 vcc, 0, v44

k2_head3:
    ds_read_b128 v[120:123], v41
    ds_read_b128 v[124:127], v41 offset:512
    v_add_u32 v41, v41, v3
    v_exp_f32 v32, v64
    v_exp_f32 v33, v65
    s_cbranch_vccnz k2_slow2
    s_waitcnt lgkmcnt(2)
    v_mfma_f32_32x32x16_bf16 v[48:63], v[8:11], v[4:7], v[80:95]
    ds_read_b128 v[12:15], v40 offset:5120
    v_exp_f32 v34, v66
    v_exp_f32 v35, v67
    v_cvt_pk_bf16_f32 v112, v32, v33
    v_exp_f32 v36, v68
    v_exp_f32 v37, v69
    v_cvt_pk_bf16_f32 v113, v34, v35
    v_mfma_f32_32x32x16_bf16 v[96:111], v[16:19], v[24:27], v[96:111]
    v_exp_f32 v38, v70
    v_exp_f32 v39, v71
    v_cvt_pk_bf16_f32 v114, v36, v37
    v_exp_f32 v32, v72
    v_exp_f32 v33, v73
    v_cvt_pk_bf16_f32 v115, v38, v39
    v_exp_f32 v34, v74
    v_exp_f32 v35, v75
    v_cvt_pk_bf16_f32 v116, v32, v33
    v_mfma_f32_32x32x16_bf16 v[96:111], v[20:23], v[28:31], v[96:111]
    v_exp_f32 v36, v76
    v_exp_f32 v37, v77
    v_cvt_pk_bf16_f32 v117, v34, v35
    v_exp_f32 v38, v78
    v_exp_f32 v39, v79
    v_cvt_pk_bf16_f32 v118, v36, v37
    v_or3_b32 v44, v112, v113, v114
    v_or3_b32 v44, v44, v115, v116
    v_cvt_pk_bf16_f32 v119, v38, v39
    v_or3_b32 v44, v44, v117, v118
    v_or_b32 v44, v44, v119
    v_and_b32 v44, 0x40004000, v44
    v_cmp_ne_u32 vcc, 0, v44

k2_head4:
    ds_read_b128 v[16:19], v41
    ds_read_b128 v[20:23], v41 offset:512
    v_add_u32 v41, v41, v3
    v_exp_f32 v32, v48
    v_exp_f32 v33, v49
    s_cbranch_vccnz k2_slow3
    s_waitcnt lgkmcnt(2)
    v_mfma_f32_32x32x16_bf16 v[64:79], v[12:15], v[4:7], v[80:95]
    ds_read_b128 v[8:11], v40 offset:6144
    v_exp_f32 v34, v50
    v_exp_f32 v35, v51
    v_cvt_pk_bf16_f32 v24, v32, v33
    v_exp_f32 v36, v52
    v_exp_f32 v37, v53
    v_cvt_pk_bf16_f32 v25, v34, v35
    v_mfma_f32_32x32x16_bf16 v[96:111], v[120:123], v[112:115], v[96:111]
    v_exp_f32 v38, v54
    v_exp_f32 v39, v55
    v_cvt_pk_bf16_f32 v26, v36, v37
    v_exp_f32 v32, v56
    v_exp_f32 v33, v57
    v_cvt_pk_bf16_f32 v27, v38, v39
    v_exp_f32 v34, v58
    v_exp_f32 v35, v59
    v_cvt_pk_bf16_f32 v28, v32, v33
    v_mfma_f32_32x32x16_bf16 v[96:111], v[124:127], v[116:119], v[96:111]
    v_exp_f32 v36, v60
    v_exp_f32 v37, v61
    v_cvt_pk_bf16_f32 v29, v34, v35
    v_exp_f32 v38, v62
    v_exp_f32 v39, v63
    v_cvt_pk_bf16_f32 v30, v36, v37
    v_or3_b32 v44, v24, v25, v26
    v_or3_b32 v44, v44, v27, v28
    v_cvt_pk_bf16_f32 v31, v38, v39
    v_or3_b32 v44, v44, v29, v30
    v_or_b32 v44, v44, v31
    v_and_b32 v44, 0x40004000, v44
    v_cmp_ne_u32 vcc, 0, v44

    s_cmp_ge_u32 s22, 7
    s_cbranch_scc1 k2_skpoll_20
k2_pollb_21:
    v_lshl_add_u32 v44, s22, 2, v42
    ds_read_b32 v44, v44 offset:4
    s_waitcnt lgkmcnt(0)
    v_readfirstlane_b32 s23, v44
    s_cmp_lt_u32 s23, 512
    s_cbranch_scc1 k2_pollb_21

k2_skpoll_20:
k2_head5:
    ds_read_b128 v[120:123], v41
    ds_read_b128 v[124:127], v41 offset:512
    v_add_u32 v41, v41, v3
    v_exp_f32 v32, v64
    v_exp_f32 v33, v65
    s_cbranch_vccnz k2_slow4
    s_waitcnt lgkmcnt(2)
    v_mfma_f32_32x32x16_bf16 v[48:63], v[8:11], v[4:7], v[80:95]
    ds_read_b128 v[12:15], v40 offset:7168
    v_exp_f32 v34, v66
    v_exp_f32 v35, v67
    v_cvt_pk_bf16_f32 v112, v32, v33
    v_exp_f32 v36, v68
    v_exp_f32 v37, v69
    v_cvt_pk_bf16_f32 v113, v34, v35
    v_mfma_f32_32x32x16_bf16 v[96:111], v[16:19], v[24:27], v[96:111]
    v_exp_f32 v38, v70
    v_exp_f32 v39, v71
    v_cvt_pk_bf16_f32 v114, v36, v37
    v_exp_f32 v32, v72
    v_exp_f32 v33, v73
    v_cvt_pk_bf16_f32 v115, v38, v39
    v_exp_f32 v34, v74
    v_exp_f32 v35, v75
    v_cvt_pk_bf16_f32 v116, v32, v33
    v_mfma_f32_32x32x16_bf16 v[96:111], v[20:23], v[28:31], v[96:111]
    v_exp_f32 v36, v76
    v_exp_f32 v37, v77
    v_cvt_pk_bf16_f32 v117, v34, v35
    v_exp_f32 v38, v78
    v_exp_f32 v39, v79
    v_cvt_pk_bf16_f32 v118, v36, v37
    v_or3_b32 v44, v112, v113, v114
    v_or3_b32 v44, v44, v115, v116
    v_cvt_pk_bf16_f32 v119, v38, v39
    v_or3_b32 v44, v44, v117, v118
    v_or_b32 v44, v44, v119
    v_and_b32 v44, 0x40004000, v44
    v_cmp_ne_u32 vcc, 0, v44

k2_head6:
    ds_read_b128 v[16:19], v41
    ds_read_b128 v[20:23], v41 offset:512
    v_add_u32 v41, v41, v3
    v_exp_f32 v32, v48
    v_exp_f32 v33, v49
    s_cbranch_vccnz k2_slow5
    s_waitcnt lgkmcnt(2)
    v_mfma_f32_32x32x16_bf16 v[64:79], v[12:15], v[4:7], v[80:95]
    ds_read_b128 v[8:11], v40 offset:8192
    v_exp_f32 v34, v50
    v_exp_f32 v35, v51
    v_cvt_pk_bf16_f32 v24, v32, v33
    v_exp_f32 v36, v52
    v_exp_f32 v37, v53
    v_cvt_pk_bf16_f32 v25, v34, v35
    v_mfma_f32_32x32x16_bf16 v[96:111], v[120:123], v[112:115], v[96:111]
    v_exp_f32 v38, v54
    v_exp_f32 v39, v55
    v_cvt_pk_bf16_f32 v26, v36, v37
    v_exp_f32 v32, v56
    v_exp_f32 v33, v57
    v_cvt_pk_bf16_f32 v27, v38, v39
    v_exp_f32 v34, v58
    v_exp_f32 v35, v59
    v_cvt_pk_bf16_f32 v28, v32, v33
    v_mfma_f32_32x32x16_bf16 v[96:111], v[124:127], v[116:119], v[96:111]
    v_exp_f32 v36, v60
    v_exp_f32 v37, v61
    v_cvt_pk_bf16_f32 v29, v34, v35
    v_exp_f32 v38, v62
    v_exp_f32 v39, v63
    v_cvt_pk_bf16_f32 v30, v36, v37
    v_or3_b32 v44, v24, v25, v26
    v_or3_b32 v44, v44, v27, v28
    v_cvt_pk_bf16_f32 v31, v38, v39
    v_or3_b32 v44, v44, v29, v30
    v_or_b32 v44, v44, v31
    v_and_b32 v44, 0x40004000, v44
    v_cmp_ne_u32 vcc, 0, v44

k2_head7:
    ds_read_b128 v[120:123], v41
    ds_read_b128 v[124:127], v41 offset:512
    v_add_u32 v41, v41, v3
    v_exp_f32 v32, v64
    v_exp_f32 v33, v65
    s_cbranch_vccnz k2_slow6
    s_waitcnt lgkmcnt(2)
    v_mfma_f32_32x32x16_bf16 v[48:63], v[8:11], v[4:7], v[80:95]
    ds_read_b128 v[12:15], v40 offset:9216
    v_exp_f32 v34, v66
    v_exp_f32 v35, v67
    v_cvt_pk_bf16_f32 v112, v32, v33
    v_exp_f32 v36, v68
    v_exp_f32 v37, v69
    v_cvt_pk_bf16_f32 v113, v34, v35
    v_mfma_f32_32x32x16_bf16 v[96:111], v[16:19], v[24:27], v[96:111]
    v_exp_f32 v38, v70
    v_exp_f32 v39, v71
    v_cvt_pk_bf16_f32 v114, v36, v37
    v_exp_f32 v32, v72
    v_exp_f32 v33, v73
    v_cvt_pk_bf16_f32 v115, v38, v39
    v_exp_f32 v34, v74
    v_exp_f32 v35, v75
    v_cvt_pk_bf16_f32 v116, v32, v33
    v_mfma_f32_32x32x16_bf16 v[96:111], v[20:23], v[28:31], v[96:111]
    v_exp_f32 v36, v76
    v_exp_f32 v37, v77
    v_cvt_pk_bf16_f32 v117, v34, v35
    v_exp_f32 v38, v78
    v_exp_f32 v39, v79
    v_cvt_pk_bf16_f32 v118, v36, v37
    v_or3_b32 v44, v112, v113, v114
    v_or3_b32 v44, v44, v115, v116
    v_cvt_pk_bf16_f32 v119, v38, v39
    v_or3_b32 v44, v44, v117, v118
    v_or_b32 v44, v44, v119
    v_and_b32 v44, 0x40004000, v44
    v_cmp_ne_u32 vcc, 0, v44

    v_add_u32 v40, 8192, v40
    s_add_u32 s22, s22, 1
    s_cmp_lt_u32 s22, 8
    s_cbranch_scc1 k2_loop

    s_nop 1
    s_cbranch_vccnz k2_slowlast
k2_fin:
    s_waitcnt lgkmcnt(0)
    v_mfma_f32_32x32x16_bf16 v[96:111], v[120:123], v[112:115], v[96:111]
    v_mfma_f32_32x32x16_bf16 v[96:111], v[124:127], v[116:119], v[96:111]
    s_nop 15
    s_nop 3
    v_mov_b32 v44, v104
    v_mov_b32 v45, v104
    s_nop 1
    v_permlane32_swap_b32 v44, v45
    s_nop 1
    v_rcp_f32 v44, v44
    s_nop 0

    v_mul_f32 v96, v96, v44
    v_mul_f32 v97, v97, v44
    v_mul_f32 v98, v98, v44
    v_mul_f32 v99, v99, v44
    v_mul_f32 v100, v100, v44
    v_mul_f32 v101, v101, v44
    v_mul_f32 v102, v102, v44
    v_mul_f32 v103, v103, v44
    v_cvt_pk_bf16_f32 v24, v96, v97
    v_cvt_pk_bf16_f32 v25, v98, v99
    v_cvt_pk_bf16_f32 v26, v100, v101
    v_cvt_pk_bf16_f32 v27, v102, v103
    s_lshl_b32 s15, s13, 5
    s_add_u32 s15, s15, 8388608
    buffer_store_dwordx4 v[24:27], v47, s[8:11], s15 offen
    s_waitcnt vmcnt(0)

    s_endpgm
k2_slow0:
    s_nop 15
    s_nop 15
    v_max3_f32 v44, v48, v49, v50
    v_max3_f32 v44, v44, v51, v52
    v_max3_f32 v44, v44, v53, v54
    v_max3_f32 v44, v44, v55, v56
    v_max3_f32 v44, v44, v57, v58
    v_max3_f32 v44, v44, v59, v60
    v_max3_f32 v44, v44, v61, v62
    v_max_f32 v44, v44, v63
    v_mov_b32 v45, v44
    s_nop 1
    v_permlane32_swap_b32 v44, v45
    s_nop 1
    v_max_f32 v44, v44, v45
    v_add_f32 v44, 0x42c00000, v44
    v_max_f32 v44, 0, v44
    v_sub_f32 v45, 0, v44
    v_exp_f32 v45, v45

    v_sub_f32 v48, v48, v44
    v_sub_f32 v64, v64, v44
    v_sub_f32 v80, v80, v44
    v_sub_f32 v49, v49, v44
    v_sub_f32 v65, v65, v44
    v_sub_f32 v81, v81, v44
    v_sub_f32 v50, v50, v44
    v_sub_f32 v66, v66, v44
    v_sub_f32 v82, v82, v44
    v_sub_f32 v51, v51, v44
    v_sub_f32 v67, v67, v44
    v_sub_f32 v83, v83, v44
    v_sub_f32 v52, v52, v44
    v_sub_f32 v68, v68, v44
    v_sub_f32 v84, v84, v44
    v_sub_f32 v53, v53, v44
    v_sub_f32 v69, v69, v44
    v_sub_f32 v85, v85, v44
    v_sub_f32 v54, v54, v44
    v_sub_f32 v70, v70, v44
    v_sub_f32 v86, v86, v44
    v_sub_f32 v55, v55, v44
    v_sub_f32 v71, v71, v44
    v_sub_f32 v87, v87, v44
    v_sub_f32 v56, v56, v44
    v_sub_f32 v72, v72, v44
    v_sub_f32 v88, v88, v44
    v_sub_f32 v57, v57, v44
    v_sub_f32 v73, v73, v44
    v_sub_f32 v89, v89, v44
    v_sub_f32 v58, v58, v44
    v_sub_f32 v74, v74, v44
    v_sub_f32 v90, v90, v44
    v_sub_f32 v59, v59, v44
    v_sub_f32 v75, v75, v44
    v_sub_f32 v91, v91, v44
    v_sub_f32 v60, v60, v44
    v_sub_f32 v76, v76, v44
    v_sub_f32 v92, v92, v44
    v_sub_f32 v61, v61, v44
    v_sub_f32 v77, v77, v44
    v_sub_f32 v93, v93, v44
    v_sub_f32 v62, v62, v44
    v_sub_f32 v78, v78, v44
    v_sub_f32 v94, v94, v44
    v_sub_f32 v63, v63, v44
    v_sub_f32 v79, v79, v44
    v_sub_f32 v95, v95, v44
    v_mul_f32 v96, v96, v45
    v_mul_f32 v97, v97, v45
    v_mul_f32 v98, v98, v45
    v_mul_f32 v99, v99, v45
    v_mul_f32 v100, v100, v45
    v_mul_f32 v101, v101, v45
    v_mul_f32 v102, v102, v45
    v_mul_f32 v103, v103, v45
    v_mul_f32 v104, v104, v45
    v_exp_f32 v32, v48
    v_exp_f32 v33, v49
    v_exp_f32 v34, v50
    v_exp_f32 v35, v51
    v_cvt_pk_bf16_f32 v24, v32, v33
    v_exp_f32 v36, v52
    v_exp_f32 v37, v53
    v_cvt_pk_bf16_f32 v25, v34, v35
    v_exp_f32 v38, v54
    v_exp_f32 v39, v55
    v_cvt_pk_bf16_f32 v26, v36, v37
    v_exp_f32 v32, v56
    v_exp_f32 v33, v57
    v_cvt_pk_bf16_f32 v27, v38, v39
    v_exp_f32 v34, v58
    v_exp_f32 v35, v59
    v_cvt_pk_bf16_f32 v28, v32, v33
    v_exp_f32 v36, v60
    v_exp_f32 v37, v61
    v_cvt_pk_bf16_f32 v29, v34, v35
    v_exp_f32 v38, v62
    v_exp_f32 v39, v63
    v_cvt_pk_bf16_f32 v30, v36, v37
    v_or3_b32 v44, v24, v25, v26
    v_or3_b32 v44, v44, v27, v28
    v_cvt_pk_bf16_f32 v31, v38, v39
    v_or3_b32 v44, v44, v29, v30
    v_or_b32 v44, v44, v31
    v_and_b32 v44, 0x40004000, v44
    v_cmp_ne_u32 vcc, 0, v44

    s_nop 1
    s_cbranch_vccnz k2_slow0
    v_sub_u32 v41, v41, v3
    s_branch k2_head1
k2_slow1:
    s_nop 15
    s_nop 15
    v_max3_f32 v44, v64, v65, v66
    v_max3_f32 v44, v44, v67, v68
    v_max3_f32 v44, v44, v69, v70
    v_max3_f32 v44, v44, v71, v72
    v_max3_f32 v44, v44, v73, v74
    v_max3_f32 v44, v44, v75, v76
    v_max3_f32 v44, v44, v77, v78
    v_max_f32 v44, v44, v79
    v_mov_b32 v45, v44
    s_nop 1
    v_permlane32_swap_b32 v44, v45
    s_nop 1
    v_max_f32 v44, v44, v45
    v_add_f32 v44, 0x42c00000, v44
    v_max_f32 v44, 0, v44
    v_sub_f32 v45, 0, v44
    v_exp_f32 v45, v45

    v_sub_f32 v64, v64, v44
    v_sub_f32 v48, v48, v44
    v_sub_f32 v80, v80, v44
    v_sub_f32 v65, v65, v44
    v_sub_f32 v49, v49, v44
    v_sub_f32 v81, v81, v44
    v_sub_f32 v66, v66, v44
    v_sub_f32 v50, v50, v44
    v_sub_f32 v82, v82, v44
    v_sub_f32 v67, v67, v44
    v_sub_f32 v51, v51, v44
    v_sub_f32 v83, v83, v44
    v_sub_f32 v68, v68, v44
    v_sub_f32 v52, v52, v44
    v_sub_f32 v84, v84, v44
    v_sub_f32 v69, v69, v44
    v_sub_f32 v53, v53, v44
    v_sub_f32 v85, v85, v44
    v_sub_f32 v70, v70, v44
    v_sub_f32 v54, v54, v44
    v_sub_f32 v86, v86, v44
    v_sub_f32 v71, v71, v44
    v_sub_f32 v55, v55, v44
    v_sub_f32 v87, v87, v44
    v_sub_f32 v72, v72, v44
    v_sub_f32 v56, v56, v44
    v_sub_f32 v88, v88, v44
    v_sub_f32 v73, v73, v44
    v_sub_f32 v57, v57, v44
    v_sub_f32 v89, v89, v44
    v_sub_f32 v74, v74, v44
    v_sub_f32 v58, v58, v44
    v_sub_f32 v90, v90, v44
    v_sub_f32 v75, v75, v44
    v_sub_f32 v59, v59, v44
    v_sub_f32 v91, v91, v44
    v_sub_f32 v76, v76, v44
    v_sub_f32 v60, v60, v44
    v_sub_f32 v92, v92, v44
    v_sub_f32 v77, v77, v44
    v_sub_f32 v61, v61, v44
    v_sub_f32 v93, v93, v44
    v_sub_f32 v78, v78, v44
    v_sub_f32 v62, v62, v44
    v_sub_f32 v94, v94, v44
    v_sub_f32 v79, v79, v44
    v_sub_f32 v63, v63, v44
    v_sub_f32 v95, v95, v44
    v_mul_f32 v96, v96, v45
    v_mul_f32 v97, v97, v45
    v_mul_f32 v98, v98, v45
    v_mul_f32 v99, v99, v45
    v_mul_f32 v100, v100, v45
    v_mul_f32 v101, v101, v45
    v_mul_f32 v102, v102, v45
    v_mul_f32 v103, v103, v45
    v_mul_f32 v104, v104, v45
    v_exp_f32 v32, v64
    v_exp_f32 v33, v65
    v_exp_f32 v34, v66
    v_exp_f32 v35, v67
    v_cvt_pk_bf16_f32 v112, v32, v33
    v_exp_f32 v36, v68
    v_exp_f32 v37, v69
    v_cvt_pk_bf16_f32 v113, v34, v35
    v_exp_f32 v38, v70
    v_exp_f32 v39, v71
    v_cvt_pk_bf16_f32 v114, v36, v37
    v_exp_f32 v32, v72
    v_exp_f32 v33, v73
    v_cvt_pk_bf16_f32 v115, v38, v39
    v_exp_f32 v34, v74
    v_exp_f32 v35, v75
    v_cvt_pk_bf16_f32 v116, v32, v33
    v_exp_f32 v36, v76
    v_exp_f32 v37, v77
    v_cvt_pk_bf16_f32 v117, v34, v35
    v_exp_f32 v38, v78
    v_exp_f32 v39, v79
    v_cvt_pk_bf16_f32 v118, v36, v37
    v_or3_b32 v44, v112, v113, v114
    v_or3_b32 v44, v44, v115, v116
    v_cvt_pk_bf16_f32 v119, v38, v39
    v_or3_b32 v44, v44, v117, v118
    v_or_b32 v44, v44, v119
    v_and_b32 v44, 0x40004000, v44
    v_cmp_ne_u32 vcc, 0, v44

    s_nop 1
    s_cbranch_vccnz k2_slow1
    v_sub_u32 v41, v41, v3
    s_branch k2_head2
k2_slow2:
    s_nop 15
    s_nop 15
    v_max3_f32 v44, v48, v49, v50
    v_max3_f32 v44, v44, v51, v52
    v_max3_f32 v44, v44, v53, v54
    v_max3_f32 v44, v44, v55, v56
    v_max3_f32 v44, v44, v57, v58
    v_max3_f32 v44, v44, v59, v60
    v_max3_f32 v44, v44, v61, v62
    v_max_f32 v44, v44, v63
    v_mov_b32 v45, v44
    s_nop 1
    v_permlane32_swap_b32 v44, v45
    s_nop 1
    v_max_f32 v44, v44, v45
    v_add_f32 v44, 0x42c00000, v44
    v_max_f32 v44, 0, v44
    v_sub_f32 v45, 0, v44
    v_exp_f32 v45, v45

    v_sub_f32 v48, v48, v44
    v_sub_f32 v64, v64, v44
    v_sub_f32 v80, v80, v44
    v_sub_f32 v49, v49, v44
    v_sub_f32 v65, v65, v44
    v_sub_f32 v81, v81, v44
    v_sub_f32 v50, v50, v44
    v_sub_f32 v66, v66, v44
    v_sub_f32 v82, v82, v44
    v_sub_f32 v51, v51, v44
    v_sub_f32 v67, v67, v44
    v_sub_f32 v83, v83, v44
    v_sub_f32 v52, v52, v44
    v_sub_f32 v68, v68, v44
    v_sub_f32 v84, v84, v44
    v_sub_f32 v53, v53, v44
    v_sub_f32 v69, v69, v44
    v_sub_f32 v85, v85, v44
    v_sub_f32 v54, v54, v44
    v_sub_f32 v70, v70, v44
    v_sub_f32 v86, v86, v44
    v_sub_f32 v55, v55, v44
    v_sub_f32 v71, v71, v44
    v_sub_f32 v87, v87, v44
    v_sub_f32 v56, v56, v44
    v_sub_f32 v72, v72, v44
    v_sub_f32 v88, v88, v44
    v_sub_f32 v57, v57, v44
    v_sub_f32 v73, v73, v44
    v_sub_f32 v89, v89, v44
    v_sub_f32 v58, v58, v44
    v_sub_f32 v74, v74, v44
    v_sub_f32 v90, v90, v44
    v_sub_f32 v59, v59, v44
    v_sub_f32 v75, v75, v44
    v_sub_f32 v91, v91, v44
    v_sub_f32 v60, v60, v44
    v_sub_f32 v76, v76, v44
    v_sub_f32 v92, v92, v44
    v_sub_f32 v61, v61, v44
    v_sub_f32 v77, v77, v44
    v_sub_f32 v93, v93, v44
    v_sub_f32 v62, v62, v44
    v_sub_f32 v78, v78, v44
    v_sub_f32 v94, v94, v44
    v_sub_f32 v63, v63, v44
    v_sub_f32 v79, v79, v44
    v_sub_f32 v95, v95, v44
    v_mul_f32 v96, v96, v45
    v_mul_f32 v97, v97, v45
    v_mul_f32 v98, v98, v45
    v_mul_f32 v99, v99, v45
    v_mul_f32 v100, v100, v45
    v_mul_f32 v101, v101, v45
    v_mul_f32 v102, v102, v45
    v_mul_f32 v103, v103, v45
    v_mul_f32 v104, v104, v45
    v_exp_f32 v32, v48
    v_exp_f32 v33, v49
    v_exp_f32 v34, v50
    v_exp_f32 v35, v51
    v_cvt_pk_bf16_f32 v24, v32, v33
    v_exp_f32 v36, v52
    v_exp_f32 v37, v53
    v_cvt_pk_bf16_f32 v25, v34, v35
    v_exp_f32 v38, v54
    v_exp_f32 v39, v55
    v_cvt_pk_bf16_f32 v26, v36, v37
    v_exp_f32 v32, v56
    v_exp_f32 v33, v57
    v_cvt_pk_bf16_f32 v27, v38, v39
    v_exp_f32 v34, v58
    v_exp_f32 v35, v59
    v_cvt_pk_bf16_f32 v28, v32, v33
    v_exp_f32 v36, v60
    v_exp_f32 v37, v61
    v_cvt_pk_bf16_f32 v29, v34, v35
    v_exp_f32 v38, v62
    v_exp_f32 v39, v63
    v_cvt_pk_bf16_f32 v30, v36, v37
    v_or3_b32 v44, v24, v25, v26
    v_or3_b32 v44, v44, v27, v28
    v_cvt_pk_bf16_f32 v31, v38, v39
    v_or3_b32 v44, v44, v29, v30
    v_or_b32 v44, v44, v31
    v_and_b32 v44, 0x40004000, v44
    v_cmp_ne_u32 vcc, 0, v44

    s_nop 1
    s_cbranch_vccnz k2_slow2
    v_sub_u32 v41, v41, v3
    s_branch k2_head3
k2_slow3:
    s_nop 15
    s_nop 15
    v_max3_f32 v44, v64, v65, v66
    v_max3_f32 v44, v44, v67, v68
    v_max3_f32 v44, v44, v69, v70
    v_max3_f32 v44, v44, v71, v72
    v_max3_f32 v44, v44, v73, v74
    v_max3_f32 v44, v44, v75, v76
    v_max3_f32 v44, v44, v77, v78
    v_max_f32 v44, v44, v79
    v_mov_b32 v45, v44
    s_nop 1
    v_permlane32_swap_b32 v44, v45
    s_nop 1
    v_max_f32 v44, v44, v45
    v_add_f32 v44, 0x42c00000, v44
    v_max_f32 v44, 0, v44
    v_sub_f32 v45, 0, v44
    v_exp_f32 v45, v45

    v_sub_f32 v64, v64, v44
    v_sub_f32 v48, v48, v44
    v_sub_f32 v80, v80, v44
    v_sub_f32 v65, v65, v44
    v_sub_f32 v49, v49, v44
    v_sub_f32 v81, v81, v44
    v_sub_f32 v66, v66, v44
    v_sub_f32 v50, v50, v44
    v_sub_f32 v82, v82, v44
    v_sub_f32 v67, v67, v44
    v_sub_f32 v51, v51, v44
    v_sub_f32 v83, v83, v44
    v_sub_f32 v68, v68, v44
    v_sub_f32 v52, v52, v44
    v_sub_f32 v84, v84, v44
    v_sub_f32 v69, v69, v44
    v_sub_f32 v53, v53, v44
    v_sub_f32 v85, v85, v44
    v_sub_f32 v70, v70, v44
    v_sub_f32 v54, v54, v44
    v_sub_f32 v86, v86, v44
    v_sub_f32 v71, v71, v44
    v_sub_f32 v55, v55, v44
    v_sub_f32 v87, v87, v44
    v_sub_f32 v72, v72, v44
    v_sub_f32 v56, v56, v44
    v_sub_f32 v88, v88, v44
    v_sub_f32 v73, v73, v44
    v_sub_f32 v57, v57, v44
    v_sub_f32 v89, v89, v44
    v_sub_f32 v74, v74, v44
    v_sub_f32 v58, v58, v44
    v_sub_f32 v90, v90, v44
    v_sub_f32 v75, v75, v44
    v_sub_f32 v59, v59, v44
    v_sub_f32 v91, v91, v44
    v_sub_f32 v76, v76, v44
    v_sub_f32 v60, v60, v44
    v_sub_f32 v92, v92, v44
    v_sub_f32 v77, v77, v44
    v_sub_f32 v61, v61, v44
    v_sub_f32 v93, v93, v44
    v_sub_f32 v78, v78, v44
    v_sub_f32 v62, v62, v44
    v_sub_f32 v94, v94, v44
    v_sub_f32 v79, v79, v44
    v_sub_f32 v63, v63, v44
    v_sub_f32 v95, v95, v44
    v_mul_f32 v96, v96, v45
    v_mul_f32 v97, v97, v45
    v_mul_f32 v98, v98, v45
    v_mul_f32 v99, v99, v45
    v_mul_f32 v100, v100, v45
    v_mul_f32 v101, v101, v45
    v_mul_f32 v102, v102, v45
    v_mul_f32 v103, v103, v45
    v_mul_f32 v104, v104, v45
    v_exp_f32 v32, v64
    v_exp_f32 v33, v65
    v_exp_f32 v34, v66
    v_exp_f32 v35, v67
    v_cvt_pk_bf16_f32 v112, v32, v33
    v_exp_f32 v36, v68
    v_exp_f32 v37, v69
    v_cvt_pk_bf16_f32 v113, v34, v35
    v_exp_f32 v38, v70
    v_exp_f32 v39, v71
    v_cvt_pk_bf16_f32 v114, v36, v37
    v_exp_f32 v32, v72
    v_exp_f32 v33, v73
    v_cvt_pk_bf16_f32 v115, v38, v39
    v_exp_f32 v34, v74
    v_exp_f32 v35, v75
    v_cvt_pk_bf16_f32 v116, v32, v33
    v_exp_f32 v36, v76
    v_exp_f32 v37, v77
    v_cvt_pk_bf16_f32 v117, v34, v35
    v_exp_f32 v38, v78
    v_exp_f32 v39, v79
    v_cvt_pk_bf16_f32 v118, v36, v37
    v_or3_b32 v44, v112, v113, v114
    v_or3_b32 v44, v44, v115, v116
    v_cvt_pk_bf16_f32 v119, v38, v39
    v_or3_b32 v44, v44, v117, v118
    v_or_b32 v44, v44, v119
    v_and_b32 v44, 0x40004000, v44
    v_cmp_ne_u32 vcc, 0, v44

    s_nop 1
    s_cbranch_vccnz k2_slow3
    v_sub_u32 v41, v41, v3
    s_branch k2_head4
k2_slow4:
    s_nop 15
    s_nop 15
    v_max3_f32 v44, v48, v49, v50
    v_max3_f32 v44, v44, v51, v52
    v_max3_f32 v44, v44, v53, v54
    v_max3_f32 v44, v44, v55, v56
    v_max3_f32 v44, v44, v57, v58
    v_max3_f32 v44, v44, v59, v60
    v_max3_f32 v44, v44, v61, v62
    v_max_f32 v44, v44, v63
    v_mov_b32 v45, v44
    s_nop 1
    v_permlane32_swap_b32 v44, v45
    s_nop 1
    v_max_f32 v44, v44, v45
    v_add_f32 v44, 0x42c00000, v44
    v_max_f32 v44, 0, v44
    v_sub_f32 v45, 0, v44
    v_exp_f32 v45, v45

    v_sub_f32 v48, v48, v44
    v_sub_f32 v64, v64, v44
    v_sub_f32 v80, v80, v44
    v_sub_f32 v49, v49, v44
    v_sub_f32 v65, v65, v44
    v_sub_f32 v81, v81, v44
    v_sub_f32 v50, v50, v44
    v_sub_f32 v66, v66, v44
    v_sub_f32 v82, v82, v44
    v_sub_f32 v51, v51, v44
    v_sub_f32 v67, v67, v44
    v_sub_f32 v83, v83, v44
    v_sub_f32 v52, v52, v44
    v_sub_f32 v68, v68, v44
    v_sub_f32 v84, v84, v44
    v_sub_f32 v53, v53, v44
    v_sub_f32 v69, v69, v44
    v_sub_f32 v85, v85, v44
    v_sub_f32 v54, v54, v44
    v_sub_f32 v70, v70, v44
    v_sub_f32 v86, v86, v44
    v_sub_f32 v55, v55, v44
    v_sub_f32 v71, v71, v44
    v_sub_f32 v87, v87, v44
    v_sub_f32 v56, v56, v44
    v_sub_f32 v72, v72, v44
    v_sub_f32 v88, v88, v44
    v_sub_f32 v57, v57, v44
    v_sub_f32 v73, v73, v44
    v_sub_f32 v89, v89, v44
    v_sub_f32 v58, v58, v44
    v_sub_f32 v74, v74, v44
    v_sub_f32 v90, v90, v44
    v_sub_f32 v59, v59, v44
    v_sub_f32 v75, v75, v44
    v_sub_f32 v91, v91, v44
    v_sub_f32 v60, v60, v44
    v_sub_f32 v76, v76, v44
    v_sub_f32 v92, v92, v44
    v_sub_f32 v61, v61, v44
    v_sub_f32 v77, v77, v44
    v_sub_f32 v93, v93, v44
    v_sub_f32 v62, v62, v44
    v_sub_f32 v78, v78, v44
    v_sub_f32 v94, v94, v44
    v_sub_f32 v63, v63, v44
    v_sub_f32 v79, v79, v44
    v_sub_f32 v95, v95, v44
    v_mul_f32 v96, v96, v45
    v_mul_f32 v97, v97, v45
    v_mul_f32 v98, v98, v45
    v_mul_f32 v99, v99, v45
    v_mul_f32 v100, v100, v45
    v_mul_f32 v101, v101, v45
    v_mul_f32 v102, v102, v45
    v_mul_f32 v103, v103, v45
    v_mul_f32 v104, v104, v45
    v_exp_f32 v32, v48
    v_exp_f32 v33, v49
    v_exp_f32 v34, v50
    v_exp_f32 v35, v51
    v_cvt_pk_bf16_f32 v24, v32, v33
    v_exp_f32 v36, v52
    v_exp_f32 v37, v53
    v_cvt_pk_bf16_f32 v25, v34, v35
    v_exp_f32 v38, v54
    v_exp_f32 v39, v55
    v_cvt_pk_bf16_f32 v26, v36, v37
    v_exp_f32 v32, v56
    v_exp_f32 v33, v57
    v_cvt_pk_bf16_f32 v27, v38, v39
    v_exp_f32 v34, v58
    v_exp_f32 v35, v59
    v_cvt_pk_bf16_f32 v28, v32, v33
    v_exp_f32 v36, v60
    v_exp_f32 v37, v61
    v_cvt_pk_bf16_f32 v29, v34, v35
    v_exp_f32 v38, v62
    v_exp_f32 v39, v63
    v_cvt_pk_bf16_f32 v30, v36, v37
    v_or3_b32 v44, v24, v25, v26
    v_or3_b32 v44, v44, v27, v28
    v_cvt_pk_bf16_f32 v31, v38, v39
    v_or3_b32 v44, v44, v29, v30
    v_or_b32 v44, v44, v31
    v_and_b32 v44, 0x40004000, v44
    v_cmp_ne_u32 vcc, 0, v44

    s_nop 1
    s_cbranch_vccnz k2_slow4
    v_sub_u32 v41, v41, v3
    s_branch k2_head5
k2_slow5:
    s_nop 15
    s_nop 15
    v_max3_f32 v44, v64, v65, v66
    v_max3_f32 v44, v44, v67, v68
    v_max3_f32 v44, v44, v69, v70
    v_max3_f32 v44, v44, v71, v72
    v_max3_f32 v44, v44, v73, v74
    v_max3_f32 v44, v44, v75, v76
    v_max3_f32 v44, v44, v77, v78
    v_max_f32 v44, v44, v79
    v_mov_b32 v45, v44
    s_nop 1
    v_permlane32_swap_b32 v44, v45
    s_nop 1
    v_max_f32 v44, v44, v45
    v_add_f32 v44, 0x42c00000, v44
    v_max_f32 v44, 0, v44
    v_sub_f32 v45, 0, v44
    v_exp_f32 v45, v45

    v_sub_f32 v64, v64, v44
    v_sub_f32 v48, v48, v44
    v_sub_f32 v80, v80, v44
    v_sub_f32 v65, v65, v44
    v_sub_f32 v49, v49, v44
    v_sub_f32 v81, v81, v44
    v_sub_f32 v66, v66, v44
    v_sub_f32 v50, v50, v44
    v_sub_f32 v82, v82, v44
    v_sub_f32 v67, v67, v44
    v_sub_f32 v51, v51, v44
    v_sub_f32 v83, v83, v44
    v_sub_f32 v68, v68, v44
    v_sub_f32 v52, v52, v44
    v_sub_f32 v84, v84, v44
    v_sub_f32 v69, v69, v44
    v_sub_f32 v53, v53, v44
    v_sub_f32 v85, v85, v44
    v_sub_f32 v70, v70, v44
    v_sub_f32 v54, v54, v44
    v_sub_f32 v86, v86, v44
    v_sub_f32 v71, v71, v44
    v_sub_f32 v55, v55, v44
    v_sub_f32 v87, v87, v44
    v_sub_f32 v72, v72, v44
    v_sub_f32 v56, v56, v44
    v_sub_f32 v88, v88, v44
    v_sub_f32 v73, v73, v44
    v_sub_f32 v57, v57, v44
    v_sub_f32 v89, v89, v44
    v_sub_f32 v74, v74, v44
    v_sub_f32 v58, v58, v44
    v_sub_f32 v90, v90, v44
    v_sub_f32 v75, v75, v44
    v_sub_f32 v59, v59, v44
    v_sub_f32 v91, v91, v44
    v_sub_f32 v76, v76, v44
    v_sub_f32 v60, v60, v44
    v_sub_f32 v92, v92, v44
    v_sub_f32 v77, v77, v44
    v_sub_f32 v61, v61, v44
    v_sub_f32 v93, v93, v44
    v_sub_f32 v78, v78, v44
    v_sub_f32 v62, v62, v44
    v_sub_f32 v94, v94, v44
    v_sub_f32 v79, v79, v44
    v_sub_f32 v63, v63, v44
    v_sub_f32 v95, v95, v44
    v_mul_f32 v96, v96, v45
    v_mul_f32 v97, v97, v45
    v_mul_f32 v98, v98, v45
    v_mul_f32 v99, v99, v45
    v_mul_f32 v100, v100, v45
    v_mul_f32 v101, v101, v45
    v_mul_f32 v102, v102, v45
    v_mul_f32 v103, v103, v45
    v_mul_f32 v104, v104, v45
    v_exp_f32 v32, v64
    v_exp_f32 v33, v65
    v_exp_f32 v34, v66
    v_exp_f32 v35, v67
    v_cvt_pk_bf16_f32 v112, v32, v33
    v_exp_f32 v36, v68
    v_exp_f32 v37, v69
    v_cvt_pk_bf16_f32 v113, v34, v35
    v_exp_f32 v38, v70
    v_exp_f32 v39, v71
    v_cvt_pk_bf16_f32 v114, v36, v37
    v_exp_f32 v32, v72
    v_exp_f32 v33, v73
    v_cvt_pk_bf16_f32 v115, v38, v39
    v_exp_f32 v34, v74
    v_exp_f32 v35, v75
    v_cvt_pk_bf16_f32 v116, v32, v33
    v_exp_f32 v36, v76
    v_exp_f32 v37, v77
    v_cvt_pk_bf16_f32 v117, v34, v35
    v_exp_f32 v38, v78
    v_exp_f32 v39, v79
    v_cvt_pk_bf16_f32 v118, v36, v37
    v_or3_b32 v44, v112, v113, v114
    v_or3_b32 v44, v44, v115, v116
    v_cvt_pk_bf16_f32 v119, v38, v39
    v_or3_b32 v44, v44, v117, v118
    v_or_b32 v44, v44, v119
    v_and_b32 v44, 0x40004000, v44
    v_cmp_ne_u32 vcc, 0, v44

    s_nop 1
    s_cbranch_vccnz k2_slow5
    v_sub_u32 v41, v41, v3
    s_branch k2_head6
k2_slow6:
    s_nop 15
    s_nop 15
    v_max3_f32 v44, v48, v49, v50
    v_max3_f32 v44, v44, v51, v52
    v_max3_f32 v44, v44, v53, v54
    v_max3_f32 v44, v44, v55, v56
    v_max3_f32 v44, v44, v57, v58
    v_max3_f32 v44, v44, v59, v60
    v_max3_f32 v44, v44, v61, v62
    v_max_f32 v44, v44, v63
    v_mov_b32 v45, v44
    s_nop 1
    v_permlane32_swap_b32 v44, v45
    s_nop 1
    v_max_f32 v44, v44, v45
    v_add_f32 v44, 0x42c00000, v44
    v_max_f32 v44, 0, v44
    v_sub_f32 v45, 0, v44
    v_exp_f32 v45, v45

    v_sub_f32 v48, v48, v44
    v_sub_f32 v64, v64, v44
    v_sub_f32 v80, v80, v44
    v_sub_f32 v49, v49, v44
    v_sub_f32 v65, v65, v44
    v_sub_f32 v81, v81, v44
    v_sub_f32 v50, v50, v44
    v_sub_f32 v66, v66, v44
    v_sub_f32 v82, v82, v44
    v_sub_f32 v51, v51, v44
    v_sub_f32 v67, v67, v44
    v_sub_f32 v83, v83, v44
    v_sub_f32 v52, v52, v44
    v_sub_f32 v68, v68, v44
    v_sub_f32 v84, v84, v44
    v_sub_f32 v53, v53, v44
    v_sub_f32 v69, v69, v44
    v_sub_f32 v85, v85, v44
    v_sub_f32 v54, v54, v44
    v_sub_f32 v70, v70, v44
    v_sub_f32 v86, v86, v44
    v_sub_f32 v55, v55, v44
    v_sub_f32 v71, v71, v44
    v_sub_f32 v87, v87, v44
    v_sub_f32 v56, v56, v44
    v_sub_f32 v72, v72, v44
    v_sub_f32 v88, v88, v44
    v_sub_f32 v57, v57, v44
    v_sub_f32 v73, v73, v44
    v_sub_f32 v89, v89, v44
    v_sub_f32 v58, v58, v44
    v_sub_f32 v74, v74, v44
    v_sub_f32 v90, v90, v44
    v_sub_f32 v59, v59, v44
    v_sub_f32 v75, v75, v44
    v_sub_f32 v91, v91, v44
    v_sub_f32 v60, v60, v44
    v_sub_f32 v76, v76, v44
    v_sub_f32 v92, v92, v44
    v_sub_f32 v61, v61, v44
    v_sub_f32 v77, v77, v44
    v_sub_f32 v93, v93, v44
    v_sub_f32 v62, v62, v44
    v_sub_f32 v78, v78, v44
    v_sub_f32 v94, v94, v44
    v_sub_f32 v63, v63, v44
    v_sub_f32 v79, v79, v44
    v_sub_f32 v95, v95, v44
    v_mul_f32 v96, v96, v45
    v_mul_f32 v97, v97, v45
    v_mul_f32 v98, v98, v45
    v_mul_f32 v99, v99, v45
    v_mul_f32 v100, v100, v45
    v_mul_f32 v101, v101, v45
    v_mul_f32 v102, v102, v45
    v_mul_f32 v103, v103, v45
    v_mul_f32 v104, v104, v45
    v_exp_f32 v32, v48
    v_exp_f32 v33, v49
    v_exp_f32 v34, v50
    v_exp_f32 v35, v51
    v_cvt_pk_bf16_f32 v24, v32, v33
    v_exp_f32 v36, v52
    v_exp_f32 v37, v53
    v_cvt_pk_bf16_f32 v25, v34, v35
    v_exp_f32 v38, v54
    v_exp_f32 v39, v55
    v_cvt_pk_bf16_f32 v26, v36, v37
    v_exp_f32 v32, v56
    v_exp_f32 v33, v57
    v_cvt_pk_bf16_f32 v27, v38, v39
    v_exp_f32 v34, v58
    v_exp_f32 v35, v59
    v_cvt_pk_bf16_f32 v28, v32, v33
    v_exp_f32 v36, v60
    v_exp_f32 v37, v61
    v_cvt_pk_bf16_f32 v29, v34, v35
    v_exp_f32 v38, v62
    v_exp_f32 v39, v63
    v_cvt_pk_bf16_f32 v30, v36, v37
    v_or3_b32 v44, v24, v25, v26
    v_or3_b32 v44, v44, v27, v28
    v_cvt_pk_bf16_f32 v31, v38, v39
    v_or3_b32 v44, v44, v29, v30
    v_or_b32 v44, v44, v31
    v_and_b32 v44, 0x40004000, v44
    v_cmp_ne_u32 vcc, 0, v44

    s_nop 1
    s_cbranch_vccnz k2_slow6
    v_sub_u32 v41, v41, v3
    s_branch k2_head7
k2_slow7:
    s_nop 15
    s_nop 15
    v_max3_f32 v44, v64, v65, v66
    v_max3_f32 v44, v44, v67, v68
    v_max3_f32 v44, v44, v69, v70
    v_max3_f32 v44, v44, v71, v72
    v_max3_f32 v44, v44, v73, v74
    v_max3_f32 v44, v44, v75, v76
    v_max3_f32 v44, v44, v77, v78
    v_max_f32 v44, v44, v79
    v_mov_b32 v45, v44
    s_nop 1
    v_permlane32_swap_b32 v44, v45
    s_nop 1
    v_max_f32 v44, v44, v45
    v_add_f32 v44, 0x42c00000, v44
    v_max_f32 v44, 0, v44
    v_sub_f32 v45, 0, v44
    v_exp_f32 v45, v45

    v_sub_f32 v64, v64, v44
    v_sub_f32 v48, v48, v44
    v_sub_f32 v80, v80, v44
    v_sub_f32 v65, v65, v44
    v_sub_f32 v49, v49, v44
    v_sub_f32 v81, v81, v44
    v_sub_f32 v66, v66, v44
    v_sub_f32 v50, v50, v44
    v_sub_f32 v82, v82, v44
    v_sub_f32 v67, v67, v44
    v_sub_f32 v51, v51, v44
    v_sub_f32 v83, v83, v44
    v_sub_f32 v68, v68, v44
    v_sub_f32 v52, v52, v44
    v_sub_f32 v84, v84, v44
    v_sub_f32 v69, v69, v44
    v_sub_f32 v53, v53, v44
    v_sub_f32 v85, v85, v44
    v_sub_f32 v70, v70, v44
    v_sub_f32 v54, v54, v44
    v_sub_f32 v86, v86, v44
    v_sub_f32 v71, v71, v44
    v_sub_f32 v55, v55, v44
    v_sub_f32 v87, v87, v44
    v_sub_f32 v72, v72, v44
    v_sub_f32 v56, v56, v44
    v_sub_f32 v88, v88, v44
    v_sub_f32 v73, v73, v44
    v_sub_f32 v57, v57, v44
    v_sub_f32 v89, v89, v44
    v_sub_f32 v74, v74, v44
    v_sub_f32 v58, v58, v44
    v_sub_f32 v90, v90, v44
    v_sub_f32 v75, v75, v44
    v_sub_f32 v59, v59, v44
    v_sub_f32 v91, v91, v44
    v_sub_f32 v76, v76, v44
    v_sub_f32 v60, v60, v44
    v_sub_f32 v92, v92, v44
    v_sub_f32 v77, v77, v44
    v_sub_f32 v61, v61, v44
    v_sub_f32 v93, v93, v44
    v_sub_f32 v78, v78, v44
    v_sub_f32 v62, v62, v44
    v_sub_f32 v94, v94, v44
    v_sub_f32 v79, v79, v44
    v_sub_f32 v63, v63, v44
    v_sub_f32 v95, v95, v44
    v_mul_f32 v96, v96, v45
    v_mul_f32 v97, v97, v45
    v_mul_f32 v98, v98, v45
    v_mul_f32 v99, v99, v45
    v_mul_f32 v100, v100, v45
    v_mul_f32 v101, v101, v45
    v_mul_f32 v102, v102, v45
    v_mul_f32 v103, v103, v45
    v_mul_f32 v104, v104, v45
    v_exp_f32 v32, v64
    v_exp_f32 v33, v65
    v_exp_f32 v34, v66
    v_exp_f32 v35, v67
    v_cvt_pk_bf16_f32 v112, v32, v33
    v_exp_f32 v36, v68
    v_exp_f32 v37, v69
    v_cvt_pk_bf16_f32 v113, v34, v35
    v_exp_f32 v38, v70
    v_exp_f32 v39, v71
    v_cvt_pk_bf16_f32 v114, v36, v37
    v_exp_f32 v32, v72
    v_exp_f32 v33, v73
    v_cvt_pk_bf16_f32 v115, v38, v39
    v_exp_f32 v34, v74
    v_exp_f32 v35, v75
    v_cvt_pk_bf16_f32 v116, v32, v33
    v_exp_f32 v36, v76
    v_exp_f32 v37, v77
    v_cvt_pk_bf16_f32 v117, v34, v35
    v_exp_f32 v38, v78
    v_exp_f32 v39, v79
    v_cvt_pk_bf16_f32 v118, v36, v37
    v_or3_b32 v44, v112, v113, v114
    v_or3_b32 v44, v44, v115, v116
    v_cvt_pk_bf16_f32 v119, v38, v39
    v_or3_b32 v44, v44, v117, v118
    v_or_b32 v44, v44, v119
    v_and_b32 v44, 0x40004000, v44
    v_cmp_ne_u32 vcc, 0, v44

    s_nop 1
    s_cbranch_vccnz k2_slow7
    v_sub_u32 v41, v41, v3
    s_branch k2_head0
k2_slowlast:
    s_nop 15
    s_nop 15
    v_max3_f32 v44, v64, v65, v66
    v_max3_f32 v44, v44, v67, v68
    v_max3_f32 v44, v44, v69, v70
    v_max3_f32 v44, v44, v71, v72
    v_max3_f32 v44, v44, v73, v74
    v_max3_f32 v44, v44, v75, v76
    v_max3_f32 v44, v44, v77, v78
    v_max_f32 v44, v44, v79
    v_mov_b32 v45, v44
    s_nop 1
    v_permlane32_swap_b32 v44, v45
    s_nop 1
    v_max_f32 v44, v44, v45
    v_add_f32 v44, 0x42c00000, v44
    v_max_f32 v44, 0, v44
    v_sub_f32 v45, 0, v44
    v_exp_f32 v45, v45

    v_sub_f32 v64, v64, v44
    v_sub_f32 v48, v48, v44
    v_sub_f32 v80, v80, v44
    v_sub_f32 v65, v65, v44
    v_sub_f32 v49, v49, v44
    v_sub_f32 v81, v81, v44
    v_sub_f32 v66, v66, v44
    v_sub_f32 v50, v50, v44
    v_sub_f32 v82, v82, v44
    v_sub_f32 v67, v67, v44
    v_sub_f32 v51, v51, v44
    v_sub_f32 v83, v83, v44
    v_sub_f32 v68, v68, v44
    v_sub_f32 v52, v52, v44
    v_sub_f32 v84, v84, v44
    v_sub_f32 v69, v69, v44
    v_sub_f32 v53, v53, v44
    v_sub_f32 v85, v85, v44
    v_sub_f32 v70, v70, v44
    v_sub_f32 v54, v54, v44
    v_sub_f32 v86, v86, v44
    v_sub_f32 v71, v71, v44
    v_sub_f32 v55, v55, v44
    v_sub_f32 v87, v87, v44
    v_sub_f32 v72, v72, v44
    v_sub_f32 v56, v56, v44
    v_sub_f32 v88, v88, v44
    v_sub_f32 v73, v73, v44
    v_sub_f32 v57, v57, v44
    v_sub_f32 v89, v89, v44
    v_sub_f32 v74, v74, v44
    v_sub_f32 v58, v58, v44
    v_sub_f32 v90, v90, v44
    v_sub_f32 v75, v75, v44
    v_sub_f32 v59, v59, v44
    v_sub_f32 v91, v91, v44
    v_sub_f32 v76, v76, v44
    v_sub_f32 v60, v60, v44
    v_sub_f32 v92, v92, v44
    v_sub_f32 v77, v77, v44
    v_sub_f32 v61, v61, v44
    v_sub_f32 v93, v93, v44
    v_sub_f32 v78, v78, v44
    v_sub_f32 v62, v62, v44
    v_sub_f32 v94, v94, v44
    v_sub_f32 v79, v79, v44
    v_sub_f32 v63, v63, v44
    v_sub_f32 v95, v95, v44
    v_mul_f32 v96, v96, v45
    v_mul_f32 v97, v97, v45
    v_mul_f32 v98, v98, v45
    v_mul_f32 v99, v99, v45
    v_mul_f32 v100, v100, v45
    v_mul_f32 v101, v101, v45
    v_mul_f32 v102, v102, v45
    v_mul_f32 v103, v103, v45
    v_mul_f32 v104, v104, v45
    v_exp_f32 v32, v64
    v_exp_f32 v33, v65
    v_exp_f32 v34, v66
    v_exp_f32 v35, v67
    v_cvt_pk_bf16_f32 v112, v32, v33
    v_exp_f32 v36, v68
    v_exp_f32 v37, v69
    v_cvt_pk_bf16_f32 v113, v34, v35
    v_exp_f32 v38, v70
    v_exp_f32 v39, v71
    v_cvt_pk_bf16_f32 v114, v36, v37
    v_exp_f32 v32, v72
    v_exp_f32 v33, v73
    v_cvt_pk_bf16_f32 v115, v38, v39
    v_exp_f32 v34, v74
    v_exp_f32 v35, v75
    v_cvt_pk_bf16_f32 v116, v32, v33
    v_exp_f32 v36, v76
    v_exp_f32 v37, v77
    v_cvt_pk_bf16_f32 v117, v34, v35
    v_exp_f32 v38, v78
    v_exp_f32 v39, v79
    v_cvt_pk_bf16_f32 v118, v36, v37
    v_or3_b32 v44, v112, v113, v114
    v_or3_b32 v44, v44, v115, v116
    v_cvt_pk_bf16_f32 v119, v38, v39
    v_or3_b32 v44, v44, v117, v118
    v_or_b32 v44, v44, v119
    v_and_b32 v44, 0x40004000, v44
    v_cmp_ne_u32 vcc, 0, v44

    s_nop 1
    s_cbranch_vccnz k2_slowlast
    s_branch k2_fin
.globl k3_kernel
.p2align 8
.type k3_kernel,@function
k3_kernel:
    s_cmp_ge_u32 s2, 256
    s_cbranch_scc1 k3_end
    s_memtime s[80:81]
    s_load_dwordx2 s[4:5], s[0:1], 0
    s_load_dwordx2 s[6:7], s[0:1], 16
    s_load_dwordx4 s[28:31], s[0:1], 64
    s_load_dwordx2 s[10:11], s[0:1], 80
    v_lshrrev_b32 v1, 6, v0
    v_and_b32 v0, 63, v0
    s_and_b32 s40, s2, 7
    s_lshl_b32 s40, s40, 2
    s_bfe_u32 s41, s2, 0x20003
    s_add_u32 s40, s40, s41
    s_lshr_b32 s41, s2, 5
    v_readfirstlane_b32 s42, v1
    s_waitcnt lgkmcnt(0)

    s_mov_b32 s12, s4
    s_and_b32 s13, s5, 0xffff
    s_mov_b32 s14, 2097152
    s_mov_b32 s15, 0x00020000
    s_mov_b32 s16, s6
    s_and_b32 s17, s7, 0xffff
    s_mov_b32 s18, 524288
    s_mov_b32 s19, 0x00020000
    s_mov_b32 s20, s28
    s_and_b32 s21, s29, 0xffff
    s_mov_b32 s22, 2097152
    s_mov_b32 s23, 0x00020000
    s_mov_b32 s24, s10
    s_and_b32 s25, s11, 0xffff
    s_mov_b32 s26, 16777216
    s_mov_b32 s27, 0x00020000
    s_add_u32 s44, s10, 10616832
    s_addc_u32 s45, s11, 0
    s_load_dwordx16 s[64:79], s[44:45], 0

    v_lshrrev_b32 v1, 3, v0
    s_lshl_b32 s46, s42, 7
    v_add_u32 v1, s46, v1
    v_and_b32 v2, 7, v0
    v_lshlrev_b32 v3, 10, v1
    v_lshl_add_u32 v3, v2, 4, v3
    s_lshl_b32 s47, s41, 7
    v_add_u32 v3, s47, v3
    v_mul_u32_u24 v4, 192, v1
    v_lshl_add_u32 v4, v2, 4, v4

    v_add_u32 v5, 0, v3
    buffer_load_dwordx4 v[16:19], v5, s[16:19], 0 offen
    v_add_u32 v5, 8192, v3
    buffer_load_dwordx4 v[20:23], v5, s[16:19], 0 offen
    v_add_u32 v5, 16384, v3
    buffer_load_dwordx4 v[24:27], v5, s[16:19], 0 offen
    v_add_u32 v5, 24576, v3
    buffer_load_dwordx4 v[28:31], v5, s[16:19], 0 offen
    v_add_u32 v5, 32768, v3
    buffer_load_dwordx4 v[32:35], v5, s[16:19], 0 offen
    v_add_u32 v5, 40960, v3
    buffer_load_dwordx4 v[36:39], v5, s[16:19], 0 offen
    v_add_u32 v5, 49152, v3
    buffer_load_dwordx4 v[40:43], v5, s[16:19], 0 offen
    v_add_u32 v5, 57344, v3
    buffer_load_dwordx4 v[44:47], v5, s[16:19], 0 offen
    v_add_u32 v5, 65536, v3
    buffer_load_dwordx4 v[48:51], v5, s[16:19], 0 offen
    v_add_u32 v5, 73728, v3
    buffer_load_dwordx4 v[52:55], v5, s[16:19], 0 offen
    v_add_u32 v5, 81920, v3
    buffer_load_dwordx4 v[56:59], v5, s[16:19], 0 offen
    v_add_u32 v5, 90112, v3
    buffer_load_dwordx4 v[60:63], v5, s[16:19], 0 offen
    v_add_u32 v5, 98304, v3
    buffer_load_dwordx4 v[64:67], v5, s[16:19], 0 offen
    v_add_u32 v5, 106496, v3
    buffer_load_dwordx4 v[68:71], v5, s[16:19], 0 offen
    v_add_u32 v5, 114688, v3
    buffer_load_dwordx4 v[72:75], v5, s[16:19], 0 offen
    v_add_u32 v5, 122880, v3
    buffer_load_dwordx4 v[76:79], v5, s[16:19], 0 offen
    v_and_b32 v5, 31, v0
    s_lshl_b32 s46, s40, 6
    s_and_b32 s47, s42, 1
    s_lshl_b32 s47, s47, 5
    s_add_u32 s46, s46, s47
    v_add_u32 v5, s46, v5
    v_lshlrev_b32 v6, 10, v5
    v_lshrrev_b32 v7, 5, v0
    v_lshl_add_u32 v6, v7, 4, v6
    s_mov_b32 s48, 8388608

    buffer_load_dwordx4 v[80:83], v6, s[24:27], s48 offen offset:0
    buffer_load_dwordx4 v[84:87], v6, s[24:27], s48 offen offset:32
    buffer_load_dwordx4 v[88:91], v6, s[24:27], s48 offen offset:64
    buffer_load_dwordx4 v[92:95], v6, s[24:27], s48 offen offset:96
    buffer_load_dwordx4 v[96:99], v6, s[24:27], s48 offen offset:128
    buffer_load_dwordx4 v[100:103], v6, s[24:27], s48 offen offset:160
    buffer_load_dwordx4 v[104:107], v6, s[24:27], s48 offen offset:192
    buffer_load_dwordx4 v[108:111], v6, s[24:27], s48 offen offset:224
    buffer_load_dwordx4 v[112:115], v6, s[24:27], s48 offen offset:256
    buffer_load_dwordx4 v[116:119], v6, s[24:27], s48 offen offset:288
    buffer_load_dwordx4 v[120:123], v6, s[24:27], s48 offen offset:320
    buffer_load_dwordx4 v[124:127], v6, s[24:27], s48 offen offset:352
    buffer_load_dwordx4 v[128:131], v6, s[24:27], s48 offen offset:384
    buffer_load_dwordx4 v[132:135], v6, s[24:27], s48 offen offset:416
    buffer_load_dwordx4 v[136:139], v6, s[24:27], s48 offen offset:448
    buffer_load_dwordx4 v[140:143], v6, s[24:27], s48 offen offset:480
    buffer_load_dwordx4 v[144:147], v6, s[24:27], s48 offen offset:512
    buffer_load_dwordx4 v[148:151], v6, s[24:27], s48 offen offset:544
    buffer_load_dwordx4 v[152:155], v6, s[24:27], s48 offen offset:576
    buffer_load_dwordx4 v[156:159], v6, s[24:27], s48 offen offset:608
    buffer_load_dwordx4 v[160:163], v6, s[24:27], s48 offen offset:640
    buffer_load_dwordx4 v[164:167], v6, s[24:27], s48 offen offset:672
    buffer_load_dwordx4 v[168:171], v6, s[24:27], s48 offen offset:704
    buffer_load_dwordx4 v[172:175], v6, s[24:27], s48 offen offset:736
    buffer_load_dwordx4 v[176:179], v6, s[24:27], s48 offen offset:768
    buffer_load_dwordx4 v[180:183], v6, s[24:27], s48 offen offset:800
    buffer_load_dwordx4 v[184:187], v6, s[24:27], s48 offen offset:832
    buffer_load_dwordx4 v[188:191], v6, s[24:27], s48 offen offset:864
    buffer_load_dwordx4 v[192:195], v6, s[24:27], s48 offen offset:896
    buffer_load_dwordx4 v[196:199], v6, s[24:27], s48 offen offset:928
    buffer_load_dwordx4 v[200:203], v6, s[24:27], s48 offen offset:960
    buffer_load_dwordx4 v[204:207], v6, s[24:27], s48 offen offset:992
    v_lshlrev_b32 v8, 10, v5
    v_lshl_add_u32 v8, v7, 3, v8
    s_lshl_b32 s46, s41, 7
    s_lshr_b32 s47, s42, 1
    s_lshl_b32 s47, s47, 6
    s_add_u32 s46, s46, s47
    v_add_u32 v8, s46, v8

    buffer_load_dwordx2 v[232:233], v8, s[12:15], 0 offen offset:0
    buffer_load_dwordx2 v[240:241], v8, s[24:27], 0 offen offset:0
    buffer_load_dwordx2 v[234:235], v8, s[12:15], 0 offen offset:16
    buffer_load_dwordx2 v[242:243], v8, s[24:27], 0 offen offset:16
    buffer_load_dwordx2 v[236:237], v8, s[12:15], 0 offen offset:32
    buffer_load_dwordx2 v[244:245], v8, s[24:27], 0 offen offset:32
    buffer_load_dwordx2 v[238:239], v8, s[12:15], 0 offen offset:48
    buffer_load_dwordx2 v[246:247], v8, s[24:27], 0 offen offset:48
    s_waitcnt vmcnt(40)
    ds_write_b128 v4, v[16:19] offset:0
    ds_write_b128 v4, v[20:23] offset:1536
    ds_write_b128 v4, v[24:27] offset:3072
    ds_write_b128 v4, v[28:31] offset:4608
    ds_write_b128 v4, v[32:35] offset:6144
    ds_write_b128 v4, v[36:39] offset:7680
    ds_write_b128 v4, v[40:43] offset:9216
    ds_write_b128 v4, v[44:47] offset:10752
    ds_write_b128 v4, v[48:51] offset:12288
    ds_write_b128 v4, v[52:55] offset:13824
    ds_write_b128 v4, v[56:59] offset:15360
    ds_write_b128 v4, v[60:63] offset:16896
    ds_write_b128 v4, v[64:67] offset:18432
    ds_write_b128 v4, v[68:71] offset:19968
    ds_write_b128 v4, v[72:75] offset:21504
    ds_write_b128 v4, v[76:79] offset:23040
    v_lshrrev_b32 v9, 5, v0
    v_lshlrev_b32 v9, 2, v9
    v_bfe_u32 v10, v0, 2, 2
    v_add_u32 v9, v9, v10
    v_mul_u32_u24 v9, 192, v9
    v_bfe_u32 v10, v0, 4, 1
    v_lshl_add_u32 v9, v10, 5, v9
    v_and_b32 v10, 3, v0
    v_lshl_add_u32 v9, v10, 3, v9
    v_add_u32 v9, s47, v9
    v_add_u32 v10, 49152, v9

    v_mov_b32 v208, 0
    v_mov_b32 v209, 0
    v_mov_b32 v210, 0
    v_mov_b32 v211, 0
    v_mov_b32 v212, 0
    v_mov_b32 v213, 0
    v_mov_b32 v214, 0
    v_mov_b32 v215, 0
    v_mov_b32 v216, 0
    v_mov_b32 v217, 0
    v_mov_b32 v218, 0
    v_mov_b32 v219, 0
    v_mov_b32 v220, 0
    v_mov_b32 v221, 0
    v_mov_b32 v222, 0
    v_mov_b32 v223, 0
    s_waitcnt lgkmcnt(0)
    s_barrier
    ds_read_b64_tr_b16 v[224:225], v9 offset:0
    ds_read_b64_tr_b16 v[226:227], v9 offset:1536
    ds_read_b64_tr_b16 v[228:229], v9 offset:3072
    ds_read_b64_tr_b16 v[230:231], v9 offset:4608
    s_waitcnt lgkmcnt(2)
    s_waitcnt vmcnt(8)
    v_mfma_f32_32x32x16_bf16 v[208:223], v[224:227], v[80:83], v[208:223]
    ds_read_b64_tr_b16 v[224:225], v9 offset:6144
    ds_read_b64_tr_b16 v[226:227], v9 offset:7680
    s_waitcnt lgkmcnt(2)
    v_mfma_f32_32x32x16_bf16 v[208:223], v[228:231], v[84:87], v[208:223]
    ds_read_b64_tr_b16 v[228:229], v9 offset:9216
    ds_read_b64_tr_b16 v[230:231], v9 offset:10752
    s_waitcnt lgkmcnt(2)
    v_mfma_f32_32x32x16_bf16 v[208:223], v[224:227], v[88:91], v[208:223]
    ds_read_b64_tr_b16 v[224:225], v9 offset:12288
    ds_read_b64_tr_b16 v[226:227], v9 offset:13824
    s_waitcnt lgkmcnt(2)
    v_mfma_f32_32x32x16_bf16 v[208:223], v[228:231], v[92:95], v[208:223]
    ds_read_b64_tr_b16 v[228:229], v9 offset:15360
    ds_read_b64_tr_b16 v[230:231], v9 offset:16896
    s_waitcnt lgkmcnt(2)
    v_mfma_f32_32x32x16_bf16 v[208:223], v[224:227], v[96:99], v[208:223]
    ds_read_b64_tr_b16 v[224:225], v9 offset:18432
    ds_read_b64_tr_b16 v[226:227], v9 offset:19968
    s_waitcnt lgkmcnt(2)
    v_mfma_f32_32x32x16_bf16 v[208:223], v[228:231], v[100:103], v[208:223]
    ds_read_b64_tr_b16 v[228:229], v9 offset:21504
    ds_read_b64_tr_b16 v[230:231], v9 offset:23040
    s_waitcnt lgkmcnt(2)
    v_mfma_f32_32x32x16_bf16 v[208:223], v[224:227], v[104:107], v[208:223]
    ds_read_b64_tr_b16 v[224:225], v9 offset:24576
    ds_read_b64_tr_b16 v[226:227], v9 offset:26112
    s_waitcnt lgkmcnt(2)
    v_mfma_f32_32x32x16_bf16 v[208:223], v[228:231], v[108:111], v[208:223]
    ds_read_b64_tr_b16 v[228:229], v9 offset:27648
    ds_read_b64_tr_b16 v[230:231], v9 offset:29184
    s_waitcnt lgkmcnt(2)
    v_mfma_f32_32x32x16_bf16 v[208:223], v[224:227], v[112:115], v[208:223]
    ds_read_b64_tr_b16 v[224:225], v9 offset:30720
    ds_read_b64_tr_b16 v[226:227], v9 offset:32256
    s_waitcnt lgkmcnt(2)
    v_mfma_f32_32x32x16_bf16 v[208:223], v[228:231], v[116:119], v[208:223]
    ds_read_b64_tr_b16 v[228:229], v9 offset:33792
    ds_read_b64_tr_b16 v[230:231], v9 offset:35328
    s_waitcnt lgkmcnt(2)
    v_mfma_f32_32x32x16_bf16 v[208:223], v[224:227], v[120:123], v[208:223]
    ds_read_b64_tr_b16 v[224:225], v9 offset:36864
    ds_read_b64_tr_b16 v[226:227], v9 offset:38400
    s_waitcnt lgkmcnt(2)
    v_mfma_f32_32x32x16_bf16 v[208:223], v[228:231], v[124:127], v[208:223]
    ds_read_b64_tr_b16 v[228:229], v9 offset:39936
    ds_read_b64_tr_b16 v[230:231], v9 offset:41472
    s_waitcnt lgkmcnt(2)
    v_mfma_f32_32x32x16_bf16 v[208:223], v[224:227], v[128:131], v[208:223]
    ds_read_b64_tr_b16 v[224:225], v9 offset:43008
    ds_read_b64_tr_b16 v[226:227], v9 offset:44544
    s_waitcnt lgkmcnt(2)
    v_mfma_f32_32x32x16_bf16 v[208:223], v[228:231], v[132:135], v[208:223]
    ds_read_b64_tr_b16 v[228:229], v9 offset:46080
    ds_read_b64_tr_b16 v[230:231], v9 offset:47616
    s_waitcnt lgkmcnt(2)
    v_mfma_f32_32x32x16_bf16 v[208:223], v[224:227], v[136:139], v[208:223]
    ds_read_b64_tr_b16 v[224:225], v10 offset:0
    ds_read_b64_tr_b16 v[226:227], v10 offset:1536
    s_waitcnt lgkmcnt(2)
    v_mfma_f32_32x32x16_bf16 v[208:223], v[228:231], v[140:143], v[208:223]
    ds_read_b64_tr_b16 v[228:229], v10 offset:3072
    ds_read_b64_tr_b16 v[230:231], v10 offset:4608
    s_waitcnt lgkmcnt(2)
    v_mfma_f32_32x32x16_bf16 v[208:223], v[224:227], v[144:147], v[208:223]
    ds_read_b64_tr_b16 v[224:225], v10 offset:6144
    ds_read_b64_tr_b16 v[226:227], v10 offset:7680
    s_waitcnt lgkmcnt(2)
    v_mfma_f32_32x32x16_bf16 v[208:223], v[228:231], v[148:151], v[208:223]
    ds_read_b64_tr_b16 v[228:229], v10 offset:9216
    ds_read_b64_tr_b16 v[230:231], v10 offset:10752
    s_waitcnt lgkmcnt(2)
    v_mfma_f32_32x32x16_bf16 v[208:223], v[224:227], v[152:155], v[208:223]
    ds_read_b64_tr_b16 v[224:225], v10 offset:12288
    ds_read_b64_tr_b16 v[226:227], v10 offset:13824
    s_waitcnt lgkmcnt(2)
    v_mfma_f32_32x32x16_bf16 v[208:223], v[228:231], v[156:159], v[208:223]
    ds_read_b64_tr_b16 v[228:229], v10 offset:15360
    ds_read_b64_tr_b16 v[230:231], v10 offset:16896
    s_waitcnt lgkmcnt(2)
    v_mfma_f32_32x32x16_bf16 v[208:223], v[224:227], v[160:163], v[208:223]
    ds_read_b64_tr_b16 v[224:225], v10 offset:18432
    ds_read_b64_tr_b16 v[226:227], v10 offset:19968
    s_waitcnt lgkmcnt(2)
    v_mfma_f32_32x32x16_bf16 v[208:223], v[228:231], v[164:167], v[208:223]
    ds_read_b64_tr_b16 v[228:229], v10 offset:21504
    ds_read_b64_tr_b16 v[230:231], v10 offset:23040
    s_waitcnt lgkmcnt(2)
    v_mfma_f32_32x32x16_bf16 v[208:223], v[224:227], v[168:171], v[208:223]
    ds_read_b64_tr_b16 v[224:225], v10 offset:24576
    ds_read_b64_tr_b16 v[226:227], v10 offset:26112
    s_waitcnt lgkmcnt(2)
    v_mfma_f32_32x32x16_bf16 v[208:223], v[228:231], v[172:175], v[208:223]
    ds_read_b64_tr_b16 v[228:229], v10 offset:27648
    ds_read_b64_tr_b16 v[230:231], v10 offset:29184
    s_waitcnt lgkmcnt(2)
    v_mfma_f32_32x32x16_bf16 v[208:223], v[224:227], v[176:179], v[208:223]
    ds_read_b64_tr_b16 v[224:225], v10 offset:30720
    ds_read_b64_tr_b16 v[226:227], v10 offset:32256
    s_waitcnt lgkmcnt(2)
    v_mfma_f32_32x32x16_bf16 v[208:223], v[228:231], v[180:183], v[208:223]
    ds_read_b64_tr_b16 v[228:229], v10 offset:33792
    ds_read_b64_tr_b16 v[230:231], v10 offset:35328
    s_waitcnt lgkmcnt(2)
    v_mfma_f32_32x32x16_bf16 v[208:223], v[224:227], v[184:187], v[208:223]
    ds_read_b64_tr_b16 v[224:225], v10 offset:36864
    ds_read_b64_tr_b16 v[226:227], v10 offset:38400
    s_waitcnt lgkmcnt(2)
    v_mfma_f32_32x32x16_bf16 v[208:223], v[228:231], v[188:191], v[208:223]
    ds_read_b64_tr_b16 v[228:229], v10 offset:39936
    ds_read_b64_tr_b16 v[230:231], v10 offset:41472
    s_waitcnt lgkmcnt(2)
    v_mfma_f32_32x32x16_bf16 v[208:223], v[224:227], v[192:195], v[208:223]
    ds_read_b64_tr_b16 v[224:225], v10 offset:43008
    ds_read_b64_tr_b16 v[226:227], v10 offset:44544
    s_waitcnt lgkmcnt(2)
    v_mfma_f32_32x32x16_bf16 v[208:223], v[228:231], v[196:199], v[208:223]
    ds_read_b64_tr_b16 v[228:229], v10 offset:46080
    ds_read_b64_tr_b16 v[230:231], v10 offset:47616
    s_waitcnt lgkmcnt(2)
    v_mfma_f32_32x32x16_bf16 v[208:223], v[224:227], v[200:203], v[208:223]
    s_waitcnt lgkmcnt(0)
    v_mfma_f32_32x32x16_bf16 v[208:223], v[228:231], v[204:207], v[208:223]
    s_waitcnt vmcnt(0) lgkmcnt(0)
    v_mov_b32 v16, 0
    v_mov_b32 v17, 0
    v_mov_b32 v18, 0
    v_mov_b32 v19, 0
    v_mov_b32 v20, 0
    v_mov_b32 v21, 0
    v_mov_b32 v22, 0
    v_mov_b32 v23, 0
    v_mov_b32 v24, 0
    v_mov_b32 v25, 0
    v_mov_b32 v26, 0
    v_mov_b32 v27, 0
    v_mov_b32 v28, 0
    v_mov_b32 v29, 0
    v_mov_b32 v30, 0
    v_mov_b32 v31, 0
    v_cmp_eq_u32 vcc, s64, v5
    s_cbranch_vccz k3_skj_22
    s_and_saveexec_b64 s[50:51], vcc
    v_lshlrev_b32 v11, 1, v8
    v_and_b32 v11, 0x7ff, v11
    s_mov_b32 s46, 10551296

    buffer_load_dwordx4 v[32:35], v11, s[24:27], s46 offen offset:0
    buffer_load_dwordx4 v[36:39], v11, s[24:27], s46 offen offset:32
    buffer_load_dwordx4 v[40:43], v11, s[24:27], s46 offen offset:64
    buffer_load_dwordx4 v[44:47], v11, s[24:27], s46 offen offset:96
    s_waitcnt vmcnt(0)
    v_cvt_pk_bf16_f32 v32, 0, v32
    v_cvt_pk_bf16_f32 v33, 0, v33
    v_cvt_pk_bf16_f32 v34, 0, v34
    v_cvt_pk_bf16_f32 v35, 0, v35
    v_cvt_pk_bf16_f32 v36, 0, v36
    v_cvt_pk_bf16_f32 v37, 0, v37
    v_cvt_pk_bf16_f32 v38, 0, v38
    v_cvt_pk_bf16_f32 v39, 0, v39
    v_cvt_pk_bf16_f32 v40, 0, v40
    v_cvt_pk_bf16_f32 v41, 0, v41
    v_cvt_pk_bf16_f32 v42, 0, v42
    v_cvt_pk_bf16_f32 v43, 0, v43
    v_cvt_pk_bf16_f32 v44, 0, v44
    v_cvt_pk_bf16_f32 v45, 0, v45
    v_cvt_pk_bf16_f32 v46, 0, v46
    v_cvt_pk_bf16_f32 v47, 0, v47
    v_mul_f32 v32, s72, v32
    v_mul_f32 v33, s72, v33
    v_mul_f32 v34, s72, v34
    v_mul_f32 v35, s72, v35
    v_mul_f32 v36, s72, v36
    v_mul_f32 v37, s72, v37
    v_mul_f32 v38, s72, v38
    v_mul_f32 v39, s72, v39
    v_mul_f32 v40, s72, v40
    v_mul_f32 v41, s72, v41
    v_mul_f32 v42, s72, v42
    v_mul_f32 v43, s72, v43
    v_mul_f32 v44, s72, v44
    v_mul_f32 v45, s72, v45
    v_mul_f32 v46, s72, v46
    v_mul_f32 v47, s72, v47
    v_cvt_pk_bf16_f32 v16, 0, v32
    v_cvt_pk_bf16_f32 v17, 0, v33
    v_cvt_pk_bf16_f32 v18, 0, v34
    v_cvt_pk_bf16_f32 v19, 0, v35
    v_cvt_pk_bf16_f32 v20, 0, v36
    v_cvt_pk_bf16_f32 v21, 0, v37
    v_cvt_pk_bf16_f32 v22, 0, v38
    v_cvt_pk_bf16_f32 v23, 0, v39
    v_cvt_pk_bf16_f32 v24, 0, v40
    v_cvt_pk_bf16_f32 v25, 0, v41
    v_cvt_pk_bf16_f32 v26, 0, v42
    v_cvt_pk_bf16_f32 v27, 0, v43
    v_cvt_pk_bf16_f32 v28, 0, v44
    v_cvt_pk_bf16_f32 v29, 0, v45
    v_cvt_pk_bf16_f32 v30, 0, v46
    v_cvt_pk_bf16_f32 v31, 0, v47
    s_mov_b64 exec, s[50:51]
k3_skj_22:
    v_cmp_eq_u32 vcc, s65, v5
    s_cbranch_vccz k3_skj_23
    s_and_saveexec_b64 s[50:51], vcc
    v_lshlrev_b32 v11, 1, v8
    v_and_b32 v11, 0x7ff, v11
    s_mov_b32 s46, 10553344

    buffer_load_dwordx4 v[32:35], v11, s[24:27], s46 offen offset:0
    buffer_load_dwordx4 v[36:39], v11, s[24:27], s46 offen offset:32
    buffer_load_dwordx4 v[40:43], v11, s[24:27], s46 offen offset:64
    buffer_load_dwordx4 v[44:47], v11, s[24:27], s46 offen offset:96
    s_waitcnt vmcnt(0)
    v_cvt_pk_bf16_f32 v32, 0, v32
    v_cvt_pk_bf16_f32 v33, 0, v33
    v_cvt_pk_bf16_f32 v34, 0, v34
    v_cvt_pk_bf16_f32 v35, 0, v35
    v_cvt_pk_bf16_f32 v36, 0, v36
    v_cvt_pk_bf16_f32 v37, 0, v37
    v_cvt_pk_bf16_f32 v38, 0, v38
    v_cvt_pk_bf16_f32 v39, 0, v39
    v_cvt_pk_bf16_f32 v40, 0, v40
    v_cvt_pk_bf16_f32 v41, 0, v41
    v_cvt_pk_bf16_f32 v42, 0, v42
    v_cvt_pk_bf16_f32 v43, 0, v43
    v_cvt_pk_bf16_f32 v44, 0, v44
    v_cvt_pk_bf16_f32 v45, 0, v45
    v_cvt_pk_bf16_f32 v46, 0, v46
    v_cvt_pk_bf16_f32 v47, 0, v47
    v_mul_f32 v32, s73, v32
    v_mul_f32 v33, s73, v33
    v_mul_f32 v34, s73, v34
    v_mul_f32 v35, s73, v35
    v_mul_f32 v36, s73, v36
    v_mul_f32 v37, s73, v37
    v_mul_f32 v38, s73, v38
    v_mul_f32 v39, s73, v39
    v_mul_f32 v40, s73, v40
    v_mul_f32 v41, s73, v41
    v_mul_f32 v42, s73, v42
    v_mul_f32 v43, s73, v43
    v_mul_f32 v44, s73, v44
    v_mul_f32 v45, s73, v45
    v_mul_f32 v46, s73, v46
    v_mul_f32 v47, s73, v47
    v_cvt_pk_bf16_f32 v16, 0, v32
    v_cvt_pk_bf16_f32 v17, 0, v33
    v_cvt_pk_bf16_f32 v18, 0, v34
    v_cvt_pk_bf16_f32 v19, 0, v35
    v_cvt_pk_bf16_f32 v20, 0, v36
    v_cvt_pk_bf16_f32 v21, 0, v37
    v_cvt_pk_bf16_f32 v22, 0, v38
    v_cvt_pk_bf16_f32 v23, 0, v39
    v_cvt_pk_bf16_f32 v24, 0, v40
    v_cvt_pk_bf16_f32 v25, 0, v41
    v_cvt_pk_bf16_f32 v26, 0, v42
    v_cvt_pk_bf16_f32 v27, 0, v43
    v_cvt_pk_bf16_f32 v28, 0, v44
    v_cvt_pk_bf16_f32 v29, 0, v45
    v_cvt_pk_bf16_f32 v30, 0, v46
    v_cvt_pk_bf16_f32 v31, 0, v47
    s_mov_b64 exec, s[50:51]
k3_skj_23:
    v_cmp_eq_u32 vcc, s66, v5
    s_cbranch_vccz k3_skj_24
    s_and_saveexec_b64 s[50:51], vcc
    v_lshlrev_b32 v11, 1, v8
    v_and_b32 v11, 0x7ff, v11
    s_mov_b32 s46, 10555392

    buffer_load_dwordx4 v[32:35], v11, s[24:27], s46 offen offset:0
    buffer_load_dwordx4 v[36:39], v11, s[24:27], s46 offen offset:32
    buffer_load_dwordx4 v[40:43], v11, s[24:27], s46 offen offset:64
    buffer_load_dwordx4 v[44:47], v11, s[24:27], s46 offen offset:96
    s_waitcnt vmcnt(0)
    v_cvt_pk_bf16_f32 v32, 0, v32
    v_cvt_pk_bf16_f32 v33, 0, v33
    v_cvt_pk_bf16_f32 v34, 0, v34
    v_cvt_pk_bf16_f32 v35, 0, v35
    v_cvt_pk_bf16_f32 v36, 0, v36
    v_cvt_pk_bf16_f32 v37, 0, v37
    v_cvt_pk_bf16_f32 v38, 0, v38
    v_cvt_pk_bf16_f32 v39, 0, v39
    v_cvt_pk_bf16_f32 v40, 0, v40
    v_cvt_pk_bf16_f32 v41, 0, v41
    v_cvt_pk_bf16_f32 v42, 0, v42
    v_cvt_pk_bf16_f32 v43, 0, v43
    v_cvt_pk_bf16_f32 v44, 0, v44
    v_cvt_pk_bf16_f32 v45, 0, v45
    v_cvt_pk_bf16_f32 v46, 0, v46
    v_cvt_pk_bf16_f32 v47, 0, v47
    v_mul_f32 v32, s74, v32
    v_mul_f32 v33, s74, v33
    v_mul_f32 v34, s74, v34
    v_mul_f32 v35, s74, v35
    v_mul_f32 v36, s74, v36
    v_mul_f32 v37, s74, v37
    v_mul_f32 v38, s74, v38
    v_mul_f32 v39, s74, v39
    v_mul_f32 v40, s74, v40
    v_mul_f32 v41, s74, v41
    v_mul_f32 v42, s74, v42
    v_mul_f32 v43, s74, v43
    v_mul_f32 v44, s74, v44
    v_mul_f32 v45, s74, v45
    v_mul_f32 v46, s74, v46
    v_mul_f32 v47, s74, v47
    v_cvt_pk_bf16_f32 v16, 0, v32
    v_cvt_pk_bf16_f32 v17, 0, v33
    v_cvt_pk_bf16_f32 v18, 0, v34
    v_cvt_pk_bf16_f32 v19, 0, v35
    v_cvt_pk_bf16_f32 v20, 0, v36
    v_cvt_pk_bf16_f32 v21, 0, v37
    v_cvt_pk_bf16_f32 v22, 0, v38
    v_cvt_pk_bf16_f32 v23, 0, v39
    v_cvt_pk_bf16_f32 v24, 0, v40
    v_cvt_pk_bf16_f32 v25, 0, v41
    v_cvt_pk_bf16_f32 v26, 0, v42
    v_cvt_pk_bf16_f32 v27, 0, v43
    v_cvt_pk_bf16_f32 v28, 0, v44
    v_cvt_pk_bf16_f32 v29, 0, v45
    v_cvt_pk_bf16_f32 v30, 0, v46
    v_cvt_pk_bf16_f32 v31, 0, v47
    s_mov_b64 exec, s[50:51]
k3_skj_24:
    v_cmp_eq_u32 vcc, s67, v5
    s_cbranch_vccz k3_skj_25
    s_and_saveexec_b64 s[50:51], vcc
    v_lshlrev_b32 v11, 1, v8
    v_and_b32 v11, 0x7ff, v11
    s_mov_b32 s46, 10557440

    buffer_load_dwordx4 v[32:35], v11, s[24:27], s46 offen offset:0
    buffer_load_dwordx4 v[36:39], v11, s[24:27], s46 offen offset:32
    buffer_load_dwordx4 v[40:43], v11, s[24:27], s46 offen offset:64
    buffer_load_dwordx4 v[44:47], v11, s[24:27], s46 offen offset:96
    s_waitcnt vmcnt(0)
    v_cvt_pk_bf16_f32 v32, 0, v32
    v_cvt_pk_bf16_f32 v33, 0, v33
    v_cvt_pk_bf16_f32 v34, 0, v34
    v_cvt_pk_bf16_f32 v35, 0, v35
    v_cvt_pk_bf16_f32 v36, 0, v36
    v_cvt_pk_bf16_f32 v37, 0, v37
    v_cvt_pk_bf16_f32 v38, 0, v38
    v_cvt_pk_bf16_f32 v39, 0, v39
    v_cvt_pk_bf16_f32 v40, 0, v40
    v_cvt_pk_bf16_f32 v41, 0, v41
    v_cvt_pk_bf16_f32 v42, 0, v42
    v_cvt_pk_bf16_f32 v43, 0, v43
    v_cvt_pk_bf16_f32 v44, 0, v44
    v_cvt_pk_bf16_f32 v45, 0, v45
    v_cvt_pk_bf16_f32 v46, 0, v46
    v_cvt_pk_bf16_f32 v47, 0, v47
    v_mul_f32 v32, s75, v32
    v_mul_f32 v33, s75, v33
    v_mul_f32 v34, s75, v34
    v_mul_f32 v35, s75, v35
    v_mul_f32 v36, s75, v36
    v_mul_f32 v37, s75, v37
    v_mul_f32 v38, s75, v38
    v_mul_f32 v39, s75, v39
    v_mul_f32 v40, s75, v40
    v_mul_f32 v41, s75, v41
    v_mul_f32 v42, s75, v42
    v_mul_f32 v43, s75, v43
    v_mul_f32 v44, s75, v44
    v_mul_f32 v45, s75, v45
    v_mul_f32 v46, s75, v46
    v_mul_f32 v47, s75, v47
    v_cvt_pk_bf16_f32 v16, 0, v32
    v_cvt_pk_bf16_f32 v17, 0, v33
    v_cvt_pk_bf16_f32 v18, 0, v34
    v_cvt_pk_bf16_f32 v19, 0, v35
    v_cvt_pk_bf16_f32 v20, 0, v36
    v_cvt_pk_bf16_f32 v21, 0, v37
    v_cvt_pk_bf16_f32 v22, 0, v38
    v_cvt_pk_bf16_f32 v23, 0, v39
    v_cvt_pk_bf16_f32 v24, 0, v40
    v_cvt_pk_bf16_f32 v25, 0, v41
    v_cvt_pk_bf16_f32 v26, 0, v42
    v_cvt_pk_bf16_f32 v27, 0, v43
    v_cvt_pk_bf16_f32 v28, 0, v44
    v_cvt_pk_bf16_f32 v29, 0, v45
    v_cvt_pk_bf16_f32 v30, 0, v46
    v_cvt_pk_bf16_f32 v31, 0, v47
    s_mov_b64 exec, s[50:51]
k3_skj_25:
    v_cmp_eq_u32 vcc, s68, v5
    s_cbranch_vccz k3_skj_26
    s_and_saveexec_b64 s[50:51], vcc
    v_lshlrev_b32 v11, 1, v8
    v_and_b32 v11, 0x7ff, v11
    s_mov_b32 s46, 10559488

    buffer_load_dwordx4 v[32:35], v11, s[24:27], s46 offen offset:0
    buffer_load_dwordx4 v[36:39], v11, s[24:27], s46 offen offset:32
    buffer_load_dwordx4 v[40:43], v11, s[24:27], s46 offen offset:64
    buffer_load_dwordx4 v[44:47], v11, s[24:27], s46 offen offset:96
    s_waitcnt vmcnt(0)
    v_cvt_pk_bf16_f32 v32, 0, v32
    v_cvt_pk_bf16_f32 v33, 0, v33
    v_cvt_pk_bf16_f32 v34, 0, v34
    v_cvt_pk_bf16_f32 v35, 0, v35
    v_cvt_pk_bf16_f32 v36, 0, v36
    v_cvt_pk_bf16_f32 v37, 0, v37
    v_cvt_pk_bf16_f32 v38, 0, v38
    v_cvt_pk_bf16_f32 v39, 0, v39
    v_cvt_pk_bf16_f32 v40, 0, v40
    v_cvt_pk_bf16_f32 v41, 0, v41
    v_cvt_pk_bf16_f32 v42, 0, v42
    v_cvt_pk_bf16_f32 v43, 0, v43
    v_cvt_pk_bf16_f32 v44, 0, v44
    v_cvt_pk_bf16_f32 v45, 0, v45
    v_cvt_pk_bf16_f32 v46, 0, v46
    v_cvt_pk_bf16_f32 v47, 0, v47
    v_mul_f32 v32, s76, v32
    v_mul_f32 v33, s76, v33
    v_mul_f32 v34, s76, v34
    v_mul_f32 v35, s76, v35
    v_mul_f32 v36, s76, v36
    v_mul_f32 v37, s76, v37
    v_mul_f32 v38, s76, v38
    v_mul_f32 v39, s76, v39
    v_mul_f32 v40, s76, v40
    v_mul_f32 v41, s76, v41
    v_mul_f32 v42, s76, v42
    v_mul_f32 v43, s76, v43
    v_mul_f32 v44, s76, v44
    v_mul_f32 v45, s76, v45
    v_mul_f32 v46, s76, v46
    v_mul_f32 v47, s76, v47
    v_cvt_pk_bf16_f32 v16, 0, v32
    v_cvt_pk_bf16_f32 v17, 0, v33
    v_cvt_pk_bf16_f32 v18, 0, v34
    v_cvt_pk_bf16_f32 v19, 0, v35
    v_cvt_pk_bf16_f32 v20, 0, v36
    v_cvt_pk_bf16_f32 v21, 0, v37
    v_cvt_pk_bf16_f32 v22, 0, v38
    v_cvt_pk_bf16_f32 v23, 0, v39
    v_cvt_pk_bf16_f32 v24, 0, v40
    v_cvt_pk_bf16_f32 v25, 0, v41
    v_cvt_pk_bf16_f32 v26, 0, v42
    v_cvt_pk_bf16_f32 v27, 0, v43
    v_cvt_pk_bf16_f32 v28, 0, v44
    v_cvt_pk_bf16_f32 v29, 0, v45
    v_cvt_pk_bf16_f32 v30, 0, v46
    v_cvt_pk_bf16_f32 v31, 0, v47
    s_mov_b64 exec, s[50:51]
k3_skj_26:
    v_cmp_eq_u32 vcc, s69, v5
    s_cbranch_vccz k3_skj_27
    s_and_saveexec_b64 s[50:51], vcc
    v_lshlrev_b32 v11, 1, v8
    v_and_b32 v11, 0x7ff, v11
    s_mov_b32 s46, 10561536

    buffer_load_dwordx4 v[32:35], v11, s[24:27], s46 offen offset:0
    buffer_load_dwordx4 v[36:39], v11, s[24:27], s46 offen offset:32
    buffer_load_dwordx4 v[40:43], v11, s[24:27], s46 offen offset:64
    buffer_load_dwordx4 v[44:47], v11, s[24:27], s46 offen offset:96
    s_waitcnt vmcnt(0)
    v_cvt_pk_bf16_f32 v32, 0, v32
    v_cvt_pk_bf16_f32 v33, 0, v33
    v_cvt_pk_bf16_f32 v34, 0, v34
    v_cvt_pk_bf16_f32 v35, 0, v35
    v_cvt_pk_bf16_f32 v36, 0, v36
    v_cvt_pk_bf16_f32 v37, 0, v37
    v_cvt_pk_bf16_f32 v38, 0, v38
    v_cvt_pk_bf16_f32 v39, 0, v39
    v_cvt_pk_bf16_f32 v40, 0, v40
    v_cvt_pk_bf16_f32 v41, 0, v41
    v_cvt_pk_bf16_f32 v42, 0, v42
    v_cvt_pk_bf16_f32 v43, 0, v43
    v_cvt_pk_bf16_f32 v44, 0, v44
    v_cvt_pk_bf16_f32 v45, 0, v45
    v_cvt_pk_bf16_f32 v46, 0, v46
    v_cvt_pk_bf16_f32 v47, 0, v47
    v_mul_f32 v32, s77, v32
    v_mul_f32 v33, s77, v33
    v_mul_f32 v34, s77, v34
    v_mul_f32 v35, s77, v35
    v_mul_f32 v36, s77, v36
    v_mul_f32 v37, s77, v37
    v_mul_f32 v38, s77, v38
    v_mul_f32 v39, s77, v39
    v_mul_f32 v40, s77, v40
    v_mul_f32 v41, s77, v41
    v_mul_f32 v42, s77, v42
    v_mul_f32 v43, s77, v43
    v_mul_f32 v44, s77, v44
    v_mul_f32 v45, s77, v45
    v_mul_f32 v46, s77, v46
    v_mul_f32 v47, s77, v47
    v_cvt_pk_bf16_f32 v16, 0, v32
    v_cvt_pk_bf16_f32 v17, 0, v33
    v_cvt_pk_bf16_f32 v18, 0, v34
    v_cvt_pk_bf16_f32 v19, 0, v35
    v_cvt_pk_bf16_f32 v20, 0, v36
    v_cvt_pk_bf16_f32 v21, 0, v37
    v_cvt_pk_bf16_f32 v22, 0, v38
    v_cvt_pk_bf16_f32 v23, 0, v39
    v_cvt_pk_bf16_f32 v24, 0, v40
    v_cvt_pk_bf16_f32 v25, 0, v41
    v_cvt_pk_bf16_f32 v26, 0, v42
    v_cvt_pk_bf16_f32 v27, 0, v43
    v_cvt_pk_bf16_f32 v28, 0, v44
    v_cvt_pk_bf16_f32 v29, 0, v45
    v_cvt_pk_bf16_f32 v30, 0, v46
    v_cvt_pk_bf16_f32 v31, 0, v47
    s_mov_b64 exec, s[50:51]
k3_skj_27:
    v_cmp_eq_u32 vcc, s70, v5
    s_cbranch_vccz k3_skj_28
    s_and_saveexec_b64 s[50:51], vcc
    v_lshlrev_b32 v11, 1, v8
    v_and_b32 v11, 0x7ff, v11
    s_mov_b32 s46, 10563584

    buffer_load_dwordx4 v[32:35], v11, s[24:27], s46 offen offset:0
    buffer_load_dwordx4 v[36:39], v11, s[24:27], s46 offen offset:32
    buffer_load_dwordx4 v[40:43], v11, s[24:27], s46 offen offset:64
    buffer_load_dwordx4 v[44:47], v11, s[24:27], s46 offen offset:96
    s_waitcnt vmcnt(0)
    v_cvt_pk_bf16_f32 v32, 0, v32
    v_cvt_pk_bf16_f32 v33, 0, v33
    v_cvt_pk_bf16_f32 v34, 0, v34
    v_cvt_pk_bf16_f32 v35, 0, v35
    v_cvt_pk_bf16_f32 v36, 0, v36
    v_cvt_pk_bf16_f32 v37, 0, v37
    v_cvt_pk_bf16_f32 v38, 0, v38
    v_cvt_pk_bf16_f32 v39, 0, v39
    v_cvt_pk_bf16_f32 v40, 0, v40
    v_cvt_pk_bf16_f32 v41, 0, v41
    v_cvt_pk_bf16_f32 v42, 0, v42
    v_cvt_pk_bf16_f32 v43, 0, v43
    v_cvt_pk_bf16_f32 v44, 0, v44
    v_cvt_pk_bf16_f32 v45, 0, v45
    v_cvt_pk_bf16_f32 v46, 0, v46
    v_cvt_pk_bf16_f32 v47, 0, v47
    v_mul_f32 v32, s78, v32
    v_mul_f32 v33, s78, v33
    v_mul_f32 v34, s78, v34
    v_mul_f32 v35, s78, v35
    v_mul_f32 v36, s78, v36
    v_mul_f32 v37, s78, v37
    v_mul_f32 v38, s78, v38
    v_mul_f32 v39, s78, v39
    v_mul_f32 v40, s78, v40
    v_mul_f32 v41, s78, v41
    v_mul_f32 v42, s78, v42
    v_mul_f32 v43, s78, v43
    v_mul_f32 v44, s78, v44
    v_mul_f32 v45, s78, v45
    v_mul_f32 v46, s78, v46
    v_mul_f32 v47, s78, v47
    v_cvt_pk_bf16_f32 v16, 0, v32
    v_cvt_pk_bf16_f32 v17, 0, v33
    v_cvt_pk_bf16_f32 v18, 0, v34
    v_cvt_pk_bf16_f32 v19, 0, v35
    v_cvt_pk_bf16_f32 v20, 0, v36
    v_cvt_pk_bf16_f32 v21, 0, v37
    v_cvt_pk_bf16_f32 v22, 0, v38
    v_cvt_pk_bf16_f32 v23, 0, v39
    v_cvt_pk_bf16_f32 v24, 0, v40
    v_cvt_pk_bf16_f32 v25, 0, v41
    v_cvt_pk_bf16_f32 v26, 0, v42
    v_cvt_pk_bf16_f32 v27, 0, v43
    v_cvt_pk_bf16_f32 v28, 0, v44
    v_cvt_pk_bf16_f32 v29, 0, v45
    v_cvt_pk_bf16_f32 v30, 0, v46
    v_cvt_pk_bf16_f32 v31, 0, v47
    s_mov_b64 exec, s[50:51]
k3_skj_28:
    v_cmp_eq_u32 vcc, s71, v5
    s_cbranch_vccz k3_skj_29
    s_and_saveexec_b64 s[50:51], vcc
    v_lshlrev_b32 v11, 1, v8
    v_and_b32 v11, 0x7ff, v11
    s_mov_b32 s46, 10565632

    buffer_load_dwordx4 v[32:35], v11, s[24:27], s46 offen offset:0
    buffer_load_dwordx4 v[36:39], v11, s[24:27], s46 offen offset:32
    buffer_load_dwordx4 v[40:43], v11, s[24:27], s46 offen offset:64
    buffer_load_dwordx4 v[44:47], v11, s[24:27], s46 offen offset:96
    s_waitcnt vmcnt(0)
    v_cvt_pk_bf16_f32 v32, 0, v32
    v_cvt_pk_bf16_f32 v33, 0, v33
    v_cvt_pk_bf16_f32 v34, 0, v34
    v_cvt_pk_bf16_f32 v35, 0, v35
    v_cvt_pk_bf16_f32 v36, 0, v36
    v_cvt_pk_bf16_f32 v37, 0, v37
    v_cvt_pk_bf16_f32 v38, 0, v38
    v_cvt_pk_bf16_f32 v39, 0, v39
    v_cvt_pk_bf16_f32 v40, 0, v40
    v_cvt_pk_bf16_f32 v41, 0, v41
    v_cvt_pk_bf16_f32 v42, 0, v42
    v_cvt_pk_bf16_f32 v43, 0, v43
    v_cvt_pk_bf16_f32 v44, 0, v44
    v_cvt_pk_bf16_f32 v45, 0, v45
    v_cvt_pk_bf16_f32 v46, 0, v46
    v_cvt_pk_bf16_f32 v47, 0, v47
    v_mul_f32 v32, s79, v32
    v_mul_f32 v33, s79, v33
    v_mul_f32 v34, s79, v34
    v_mul_f32 v35, s79, v35
    v_mul_f32 v36, s79, v36
    v_mul_f32 v37, s79, v37
    v_mul_f32 v38, s79, v38
    v_mul_f32 v39, s79, v39
    v_mul_f32 v40, s79, v40
    v_mul_f32 v41, s79, v41
    v_mul_f32 v42, s79, v42
    v_mul_f32 v43, s79, v43
    v_mul_f32 v44, s79, v44
    v_mul_f32 v45, s79, v45
    v_mul_f32 v46, s79, v46
    v_mul_f32 v47, s79, v47
    v_cvt_pk_bf16_f32 v16, 0, v32
    v_cvt_pk_bf16_f32 v17, 0, v33
    v_cvt_pk_bf16_f32 v18, 0, v34
    v_cvt_pk_bf16_f32 v19, 0, v35
    v_cvt_pk_bf16_f32 v20, 0, v36
    v_cvt_pk_bf16_f32 v21, 0, v37
    v_cvt_pk_bf16_f32 v22, 0, v38
    v_cvt_pk_bf16_f32 v23, 0, v39
    v_cvt_pk_bf16_f32 v24, 0, v40
    v_cvt_pk_bf16_f32 v25, 0, v41
    v_cvt_pk_bf16_f32 v26, 0, v42
    v_cvt_pk_bf16_f32 v27, 0, v43
    v_cvt_pk_bf16_f32 v28, 0, v44
    v_cvt_pk_bf16_f32 v29, 0, v45
    v_cvt_pk_bf16_f32 v30, 0, v46
    v_cvt_pk_bf16_f32 v31, 0, v47
    s_mov_b64 exec, s[50:51]
k3_skj_29:
    s_nop 7
    v_cvt_pk_bf16_f32 v208, 0, v208
    v_lshlrev_b32 v32, 16, v232
    v_lshlrev_b32 v48, 16, v240
    v_cvt_pk_bf16_f32 v209, 0, v209
    v_and_b32 v33, 0xffff0000, v232
    v_and_b32 v49, 0xffff0000, v240
    v_cvt_pk_bf16_f32 v210, 0, v210
    v_lshlrev_b32 v34, 16, v233
    v_lshlrev_b32 v50, 16, v241
    v_cvt_pk_bf16_f32 v211, 0, v211
    v_and_b32 v35, 0xffff0000, v233
    v_and_b32 v51, 0xffff0000, v241
    v_add_f32 v208, v208, v32
    v_add_f32 v16, v16, v48
    v_add_f32 v209, v209, v33
    v_add_f32 v17, v17, v49
    v_add_f32 v210, v210, v34
    v_add_f32 v18, v18, v50
    v_add_f32 v211, v211, v35
    v_add_f32 v19, v19, v51
    v_cvt_pk_bf16_f32 v208, 0, v208
    v_cvt_pk_bf16_f32 v16, 0, v16
    v_cvt_pk_bf16_f32 v209, 0, v209
    v_cvt_pk_bf16_f32 v17, 0, v17
    v_cvt_pk_bf16_f32 v210, 0, v210
    v_cvt_pk_bf16_f32 v18, 0, v18
    v_cvt_pk_bf16_f32 v211, 0, v211
    v_cvt_pk_bf16_f32 v19, 0, v19
    v_add_f32 v208, v208, v16
    v_add_f32 v209, v209, v17
    v_add_f32 v210, v210, v18
    v_add_f32 v211, v211, v19
    v_cvt_pk_bf16_f32 v64, v208, v209
    v_cvt_pk_bf16_f32 v65, v210, v211
    buffer_store_dwordx2 v[64:65], v8, s[20:23], 0 offen offset:0
    v_cvt_pk_bf16_f32 v212, 0, v212
    v_lshlrev_b32 v36, 16, v234
    v_lshlrev_b32 v52, 16, v242
    v_cvt_pk_bf16_f32 v213, 0, v213
    v_and_b32 v37, 0xffff0000, v234
    v_and_b32 v53, 0xffff0000, v242
    v_cvt_pk_bf16_f32 v214, 0, v214
    v_lshlrev_b32 v38, 16, v235
    v_lshlrev_b32 v54, 16, v243
    v_cvt_pk_bf16_f32 v215, 0, v215
    v_and_b32 v39, 0xffff0000, v235
    v_and_b32 v55, 0xffff0000, v243
    v_add_f32 v212, v212, v36
    v_add_f32 v20, v20, v52
    v_add_f32 v213, v213, v37
    v_add_f32 v21, v21, v53
    v_add_f32 v214, v214, v38
    v_add_f32 v22, v22, v54
    v_add_f32 v215, v215, v39
    v_add_f32 v23, v23, v55
    v_cvt_pk_bf16_f32 v212, 0, v212
    v_cvt_pk_bf16_f32 v20, 0, v20
    v_cvt_pk_bf16_f32 v213, 0, v213
    v_cvt_pk_bf16_f32 v21, 0, v21
    v_cvt_pk_bf16_f32 v214, 0, v214
    v_cvt_pk_bf16_f32 v22, 0, v22
    v_cvt_pk_bf16_f32 v215, 0, v215
    v_cvt_pk_bf16_f32 v23, 0, v23
    v_add_f32 v212, v212, v20
    v_add_f32 v213, v213, v21
    v_add_f32 v214, v214, v22
    v_add_f32 v215, v215, v23
    v_cvt_pk_bf16_f32 v66, v212, v213
    v_cvt_pk_bf16_f32 v67, v214, v215
    buffer_store_dwordx2 v[66:67], v8, s[20:23], 0 offen offset:16
    v_cvt_pk_bf16_f32 v216, 0, v216
    v_lshlrev_b32 v40, 16, v236
    v_lshlrev_b32 v56, 16, v244
    v_cvt_pk_bf16_f32 v217, 0, v217
    v_and_b32 v41, 0xffff0000, v236
    v_and_b32 v57, 0xffff0000, v244
    v_cvt_pk_bf16_f32 v218, 0, v218
    v_lshlrev_b32 v42, 16, v237
    v_lshlrev_b32 v58, 16, v245
    v_cvt_pk_bf16_f32 v219, 0, v219
    v_and_b32 v43, 0xffff0000, v237
    v_and_b32 v59, 0xffff0000, v245
    v_add_f32 v216, v216, v40
    v_add_f32 v24, v24, v56
    v_add_f32 v217, v217, v41
    v_add_f32 v25, v25, v57
    v_add_f32 v218, v218, v42
    v_add_f32 v26, v26, v58
    v_add_f32 v219, v219, v43
    v_add_f32 v27, v27, v59
    v_cvt_pk_bf16_f32 v216, 0, v216
    v_cvt_pk_bf16_f32 v24, 0, v24
    v_cvt_pk_bf16_f32 v217, 0, v217
    v_cvt_pk_bf16_f32 v25, 0, v25
    v_cvt_pk_bf16_f32 v218, 0, v218
    v_cvt_pk_bf16_f32 v26, 0, v26
    v_cvt_pk_bf16_f32 v219, 0, v219
    v_cvt_pk_bf16_f32 v27, 0, v27
    v_add_f32 v216, v216, v24
    v_add_f32 v217, v217, v25
    v_add_f32 v218, v218, v26
    v_add_f32 v219, v219, v27
    v_cvt_pk_bf16_f32 v68, v216, v217
    v_cvt_pk_bf16_f32 v69, v218, v219
    buffer_store_dwordx2 v[68:69], v8, s[20:23], 0 offen offset:32
    v_cvt_pk_bf16_f32 v220, 0, v220
    v_lshlrev_b32 v44, 16, v238
    v_lshlrev_b32 v60, 16, v246
    v_cvt_pk_bf16_f32 v221, 0, v221
    v_and_b32 v45, 0xffff0000, v238
    v_and_b32 v61, 0xffff0000, v246
    v_cvt_pk_bf16_f32 v222, 0, v222
    v_lshlrev_b32 v46, 16, v239
    v_lshlrev_b32 v62, 16, v247
    v_cvt_pk_bf16_f32 v223, 0, v223
    v_and_b32 v47, 0xffff0000, v239
    v_and_b32 v63, 0xffff0000, v247
    v_add_f32 v220, v220, v44
    v_add_f32 v28, v28, v60
    v_add_f32 v221, v221, v45
    v_add_f32 v29, v29, v61
    v_add_f32 v222, v222, v46
    v_add_f32 v30, v30, v62
    v_add_f32 v223, v223, v47
    v_add_f32 v31, v31, v63
    v_cvt_pk_bf16_f32 v220, 0, v220
    v_cvt_pk_bf16_f32 v28, 0, v28
    v_cvt_pk_bf16_f32 v221, 0, v221
    v_cvt_pk_bf16_f32 v29, 0, v29
    v_cvt_pk_bf16_f32 v222, 0, v222
    v_cvt_pk_bf16_f32 v30, 0, v30
    v_cvt_pk_bf16_f32 v223, 0, v223
    v_cvt_pk_bf16_f32 v31, 0, v31
    v_add_f32 v220, v220, v28
    v_add_f32 v221, v221, v29
    v_add_f32 v222, v222, v30
    v_add_f32 v223, v223, v31
    v_cvt_pk_bf16_f32 v70, v220, v221
    v_cvt_pk_bf16_f32 v71, v222, v223
    buffer_store_dwordx2 v[70:71], v8, s[20:23], 0 offen offset:48
    s_waitcnt vmcnt(0)
k3_end:
    s_endpgm
.section .rodata,"a"
.p2align 6
.amdhsa_kernel k1_kernel
  .amdhsa_next_free_vgpr 240
  .amdhsa_next_free_sgpr 102
  .amdhsa_accum_offset 240
  .amdhsa_group_segment_fixed_size 0
  .amdhsa_kernarg_size 88
  .amdhsa_user_sgpr_count 2
  .amdhsa_user_sgpr_kernarg_segment_ptr 1
  .amdhsa_system_sgpr_workgroup_id_x 1
.end_amdhsa_kernel
.p2align 6
.amdhsa_kernel k2_kernel
  .amdhsa_next_free_vgpr 128
  .amdhsa_next_free_sgpr 102
  .amdhsa_accum_offset 128
  .amdhsa_group_segment_fixed_size 0
  .amdhsa_kernarg_size 88
  .amdhsa_user_sgpr_count 2
  .amdhsa_user_sgpr_kernarg_segment_ptr 1
  .amdhsa_system_sgpr_workgroup_id_x 1
.end_amdhsa_kernel
.p2align 6
.amdhsa_kernel k3_kernel
  .amdhsa_next_free_vgpr 256
  .amdhsa_next_free_sgpr 102
  .amdhsa_accum_offset 256
  .amdhsa_group_segment_fixed_size 0
  .amdhsa_kernarg_size 88
  .amdhsa_user_sgpr_count 2
  .amdhsa_user_sgpr_kernarg_segment_ptr 1
  .amdhsa_system_sgpr_workgroup_id_x 1
.end_amdhsa_kernel
```
